```python
import torch

def _softmax(x, axis=-1):
    return torch.softmax(x, dim=axis)
def _gelu(x):
    return torch.nn.functional.gelu(x, approximate="tanh")
def _silu(x):
    return torch.nn.functional.silu(x)
def _sigmoid(x):
    return torch.sigmoid(x)
def _layernorm(x, axis=-1, eps=1e-5):
    m = x.mean(dim=axis, keepdim=True)
    v = x.var(dim=axis, keepdim=True, unbiased=False)
    return (x - m) / torch.sqrt(v + eps)
def _scatter_add(tgt, idx, src, axis=0):
    return tgt.clone().index_add_(axis, idx, src)
def _segment_sum(src, seg, n):
    out = torch.zeros((n,) + src.shape[1:], dtype=src.dtype)
    return out.index_add_(0, seg, src)
def _pad(x, pw):
    flat = tuple(v for pair in reversed(pw) for v in pair)
    return torch.nn.functional.pad(x, flat)

kernel_name = 'concat_heads__gqa_block_cached__mha_block_cached__near_ridge'

def setup_inputs():

    _w = (lambda a: (lambda t: t.to(torch.bfloat16) if t.is_floating_point() else t)(torch.as_tensor(a)))
    def _A_setup():
        B, Sq, D = 8, 96, 448
        Hq, Hkv, Sk, Dh = 16, 8, 1024, 256
        assert Hq % Hkv == 0, (Hq, Hkv)
        return {
            "x": _w((lambda *s: torch.randn(*s, dtype=torch.bfloat16) * 0.8)(B, Sq, D)),
            "k_cache": _w((lambda *s: torch.randn(*s, dtype=torch.bfloat16) * 0.8)(B, Hkv, Sk, Dh)),
            "v_cache": _w((lambda *s: torch.randn(*s, dtype=torch.bfloat16) * 0.05)(B, Hkv, Sk, Dh)),
            "wq": _w((lambda *s: torch.randn(*s, dtype=torch.bfloat16) * 0.8)(D, Hq * Dh) * (D ** -0.5)),
            "wo": _w((lambda *s: torch.randn(*s, dtype=torch.bfloat16) * 0.05)(Hq * Dh, D) * ((Hq * Dh) ** -0.5)),
        }
    _A_in = _A_setup()

    def _B_setup():
        B, Sq, D = 8, 96, 448
        H, Sk, Dh = 16, 1024, 256
        return {
            "x": _w((lambda *s: torch.randn(*s, dtype=torch.bfloat16) * 0.8)(B, Sq, D)),
            "k_cache": _w((lambda *s: torch.randn(*s, dtype=torch.bfloat16) * 0.8)(B, H, Sk, Dh)),
            "v_cache": _w((lambda *s: torch.randn(*s, dtype=torch.bfloat16) * 0.05)(B, H, Sk, Dh)),
            "wq": _w((lambda *s: torch.randn(*s, dtype=torch.bfloat16) * 0.8)(D, H * Dh) * (D ** -0.5)),
            "wo": _w((lambda *s: torch.randn(*s, dtype=torch.bfloat16) * 0.05)(H * Dh, D) * ((H * Dh) ** -0.5)),
        }
    _B_in = _B_setup()

    return {
        "A_x": _A_in["x"],
        "A_k_cache": _A_in["k_cache"],
        "A_v_cache": _A_in["v_cache"],
        "A_wq": _A_in["wq"],
        "A_wo": _A_in["wo"],
        "B_x": _B_in["x"],
        "B_k_cache": _B_in["k_cache"],
        "B_v_cache": _B_in["v_cache"],
        "B_wq": _B_in["wq"],
        "B_wo": _B_in["wo"],
    }

def reference(A_x, A_k_cache, A_v_cache, A_wq, A_wo, B_x, B_k_cache, B_v_cache, B_wq, B_wo):
    def _A_ref(x, k_cache, v_cache, wq, wo):
        B, Sq, D = x.shape
        Hq, Dh = 16, 256
        Hkv = k_cache.shape[1]
        rep = Hq // Hkv
        q = (lambda x, *d: x.permute(*d))((x @ wq).reshape(B, Sq, Hq, Dh), 0, 2, 1, 3)
        k = (lambda x, n, axis: torch.repeat_interleave(x, n, dim=axis))(k_cache, rep, axis=1)
        v = (lambda x, n, axis: torch.repeat_interleave(x, n, dim=axis))(v_cache, rep, axis=1)
        scores = torch.einsum("bhqd,bhkd->bhqk", q, k) * (Dh ** -0.5)
        p = _softmax(scores, axis=-1)
        o = torch.einsum("bhqk,bhkd->bhqd", p, v)
        return (lambda x, *d: x.permute(*d))(o, 0, 2, 1, 3).reshape(B, Sq, Hq * Dh) @ wo

    def _B_ref(x, k_cache, v_cache, wq, wo):
        B, Sq, D = x.shape
        H, Dh = 16, 256
        q = (lambda x, *d: x.permute(*d))((x @ wq).reshape(B, Sq, H, Dh), 0, 2, 1, 3)
        scores = torch.einsum("bhqd,bhkd->bhqk", q, k_cache) * (Dh ** -0.5)
        p = _softmax(scores, axis=-1)
        o = torch.einsum("bhqk,bhkd->bhqd", p, v_cache)
        return (lambda x, *d: x.permute(*d))(o, 0, 2, 1, 3).reshape(B, Sq, H * Dh) @ wo

    a = _A_ref(A_x, A_k_cache, A_v_cache, A_wq, A_wo)
    b = _B_ref(B_x, B_k_cache, B_v_cache, B_wq, B_wo)
    return torch.concatenate([a, b], axis=-1)
```

```asm
; @launch grid=(256,1,1) block=(256,1,1) lds=163840
.amdgcn_target "amdgcn-amd-amdhsa--gfx950"
.text
.globl concat_heads__gqa_block_cached__mha_block_cached__near_ridge_kernel
.p2align 12
.p2align 8
.type concat_heads__gqa_block_cached__mha_block_cached__near_ridge_kernel,@function
concat_heads__gqa_block_cached__mha_block_cached__near_ridge_kernel:
L_code0:
    s_cmp_ge_u32 s2, 256
    s_cbranch_scc1 L_exit0
    s_bfe_u32 s22, s2, 0x10003
    s_mul_i32 s3, s22, 40
    s_load_dwordx8 s[4:11], s[0:1], s3
    s_add_u32 s3, s3, 32
    s_load_dwordx2 s[12:13], s[0:1], s3
    s_load_dwordx2 s[18:19], s[0:1], 80
    s_load_dwordx2 s[16:17], s[0:1], 88
    s_load_dwordx2 s[14:15], s[0:1], 96
    v_lshrrev_b32 v2, 6, v0
    v_and_b32 v1, 63, v0
    v_readfirstlane_b32 s27, v2
    s_and_b32 s20, s2, 7
    s_bfe_u32 s23, s2, 0x10004
    s_lshr_b32 s24, s2, 5
    s_lshl_b32 s25, s20, 1
    s_add_u32 s25, s25, s23
    s_lshl_b32 s54, s24, 4
    s_add_u32 s54, s54, s25
    s_lshr_b32 s26, s54, 1
    s_cmp_eq_u32 s22, 0
    s_cselect_b32 s26, s26, s54
    s_lshl_b32 s69, s22, 3
    s_add_u32 s69, s69, s24
    s_cmp_eq_u32 s27, 0
    s_cbranch_scc0 L_compute
    v_lshrrev_b32 v2, 5, v1
    v_and_b32 v3, 31, v1
    v_lshrrev_b32 v4, 3, v1
    v_and_b32 v5, 7, v1
    v_lshrrev_b32 v6, 4, v1
    v_mul_u32_u24 v4, 896, v4
    v_xor_b32 v7, v6, v5
    v_lshl_add_u32 v8, v7, 4, v4
    v_xor_b32 v9, 64, v8
    v_add_u32 v10, 12288, v8
    v_add_u32 v11, 18432, v9
    v_add_u32 v9, 6144, v9
    v_lshlrev_b32 v7, 1, v2
    v_xor_b32 v7, v7, v3
    v_lshlrev_b32 v12, 4, v7
    v_lshl_add_u32 v32, v2, 13, v12
    v_xor_b32 v33, 64, v32
    v_add_u32 v34, 30720, v32
    v_add_u32 v35, 46080, v33
    v_add_u32 v33, 15360, v33
    v_xor_b32 v36, 128, v32
    v_xor_b32 v37, 128, v33
    v_xor_b32 v38, 128, v34
    v_xor_b32 v39, 128, v35
    s_cmp_eq_u32 s24, 7
    s_cselect_b32 s59, 0, s24
    s_mul_i32 s58, s23, 0
    s_and_b32 s54, s24, 6
    s_add_u32 s58, s58, s54
    s_sub_u32 s54, s58, 7
    s_cselect_b32 s58, s58, s54
    s_mul_i32 s54, s24, 86016
    s_lshl_b32 s55, s25, 9
    s_waitcnt lgkmcnt(0)
    s_add_u32 s28, s4, s54
    s_addc_u32 s29, s5, 0
    s_mov_b32 s30, 86016
    s_mov_b32 s31, 0x20000
    s_add_u32 s32, s10, s55
    s_addc_u32 s33, s11, 0
    s_sub_u32 s34, 3670016, s55
    s_mov_b32 s35, 0x20000
    s_mov_b32 s52, 49152
    s_lshl_b32 s53, s58, 7
    s_mov_b32 m0, s52
    s_waitcnt vmcnt(59)
    buffer_load_dwordx4 v8, s[28:31], s53 offen offset:0  lds
    buffer_load_dwordx4 v9, s[28:31], s53 offen offset:1024  lds
    buffer_load_dwordx4 v10, s[28:31], s53 offen offset:2048  lds
    buffer_load_dwordx4 v11, s[28:31], s53 offen offset:3072  lds
    s_add_u32 m0, s52, 4096
    s_add_u32 s53, s53, 28672
    s_waitcnt vmcnt(59)
    buffer_load_dwordx4 v8, s[28:31], s53 offen offset:0  lds
    buffer_load_dwordx4 v9, s[28:31], s53 offen offset:1024  lds
    buffer_load_dwordx4 v10, s[28:31], s53 offen offset:2048  lds
    buffer_load_dwordx4 v11, s[28:31], s53 offen offset:3072  lds
    s_add_u32 m0, s52, 8192
    s_add_u32 s53, s53, 28672
    s_waitcnt vmcnt(59)
    buffer_load_dwordx4 v8, s[28:31], s53 offen offset:0  lds
    buffer_load_dwordx4 v9, s[28:31], s53 offen offset:1024  lds
    buffer_load_dwordx4 v10, s[28:31], s53 offen offset:2048  lds
    buffer_load_dwordx4 v11, s[28:31], s53 offen offset:3072  lds
    s_mov_b32 s52, 65536
    s_lshl_b32 s53, s58, 19
    s_mov_b32 m0, s52
    s_waitcnt vmcnt(59)
    buffer_load_dwordx4 v32, s[32:35], s53 offen offset:0  lds
    buffer_load_dwordx4 v33, s[32:35], s53 offen offset:1024  lds
    buffer_load_dwordx4 v34, s[32:35], s53 offen offset:2048  lds
    buffer_load_dwordx4 v35, s[32:35], s53 offen offset:3072  lds
    s_add_u32 m0, s52, 4096
    s_add_u32 s53, s53, 65536
    s_waitcnt vmcnt(59)
    buffer_load_dwordx4 v36, s[32:35], s53 offen offset:0  lds
    buffer_load_dwordx4 v37, s[32:35], s53 offen offset:1024  lds
    buffer_load_dwordx4 v38, s[32:35], s53 offen offset:2048  lds
    buffer_load_dwordx4 v39, s[32:35], s53 offen offset:3072  lds
    s_add_u32 m0, s52, 8192
    s_add_u32 s53, s53, 65536
    s_waitcnt vmcnt(59)
    buffer_load_dwordx4 v32, s[32:35], s53 offen offset:0  lds
    buffer_load_dwordx4 v33, s[32:35], s53 offen offset:1024  lds
    buffer_load_dwordx4 v34, s[32:35], s53 offen offset:2048  lds
    buffer_load_dwordx4 v35, s[32:35], s53 offen offset:3072  lds
    s_add_u32 m0, s52, 12288
    s_add_u32 s53, s53, 65536
    s_waitcnt vmcnt(59)
    buffer_load_dwordx4 v36, s[32:35], s53 offen offset:0  lds
    buffer_load_dwordx4 v37, s[32:35], s53 offen offset:1024  lds
    buffer_load_dwordx4 v38, s[32:35], s53 offen offset:2048  lds
    buffer_load_dwordx4 v39, s[32:35], s53 offen offset:3072  lds
    s_mov_b32 s52, 81920
    s_lshl_b32 s53, s58, 19
    s_add_u32 s53, s53, 262144
    s_add_u32 s58, s58, 1
    s_cmp_eq_u32 s58, 7
    s_cselect_b32 s58, 0, s58
    s_mov_b32 m0, s52
    s_waitcnt vmcnt(59)
    buffer_load_dwordx4 v32, s[32:35], s53 offen offset:0  lds
    buffer_load_dwordx4 v33, s[32:35], s53 offen offset:1024  lds
    buffer_load_dwordx4 v34, s[32:35], s53 offen offset:2048  lds
    buffer_load_dwordx4 v35, s[32:35], s53 offen offset:3072  lds
    s_add_u32 m0, s52, 4096
    s_add_u32 s53, s53, 65536
    s_waitcnt vmcnt(59)
    buffer_load_dwordx4 v36, s[32:35], s53 offen offset:0  lds
    buffer_load_dwordx4 v37, s[32:35], s53 offen offset:1024  lds
    buffer_load_dwordx4 v38, s[32:35], s53 offen offset:2048  lds
    buffer_load_dwordx4 v39, s[32:35], s53 offen offset:3072  lds
    s_add_u32 m0, s52, 8192
    s_add_u32 s53, s53, 65536
    s_waitcnt vmcnt(59)
    buffer_load_dwordx4 v32, s[32:35], s53 offen offset:0  lds
    buffer_load_dwordx4 v33, s[32:35], s53 offen offset:1024  lds
    buffer_load_dwordx4 v34, s[32:35], s53 offen offset:2048  lds
    buffer_load_dwordx4 v35, s[32:35], s53 offen offset:3072  lds
    s_add_u32 m0, s52, 12288
    s_add_u32 s53, s53, 65536
    s_waitcnt vmcnt(59)
    buffer_load_dwordx4 v36, s[32:35], s53 offen offset:0  lds
    buffer_load_dwordx4 v37, s[32:35], s53 offen offset:1024  lds
    buffer_load_dwordx4 v38, s[32:35], s53 offen offset:2048  lds
    buffer_load_dwordx4 v39, s[32:35], s53 offen offset:3072  lds
    s_lshl_b32 s54, s26, 19
    s_add_u32 s36, s6, s54
    s_addc_u32 s37, s7, 0
    s_mov_b32 s38, 0x80000
    s_mov_b32 s39, 0x20000
    s_add_u32 s40, s8, s54
    s_addc_u32 s41, s9, 0
    s_mov_b32 s42, 0x80000
    s_mov_b32 s43, 0x20000
    s_mul_i32 s54, s25, 229376
    s_add_u32 s44, s12, s54
    s_addc_u32 s45, s13, 0
    s_mov_b32 s46, 229376
    s_mov_b32 s47, 0x20000
    s_mul_i32 s63, s26, 16
    s_and_b32 s63, s63, 31
    s_lshl_b32 s63, s63, 14
    s_mov_b32 s86, 0
    v_xor_b32 v7, v2, v3
    v_lshlrev_b32 v7, 4, v7
    v_lshl_add_u32 v16, v2, 9, v7
    v_xor_b32 v17, 32, v16
    v_xor_b32 v18, 64, v16
    v_xor_b32 v19, 96, v16
    v_xor_b32 v20, 128, v16
    v_xor_b32 v21, 160, v16
    v_xor_b32 v22, 192, v16
    v_xor_b32 v23, 224, v16
    v_lshl_add_u32 v24, v2, 9, v12
    v_xor_b32 v25, 64, v24
    v_xor_b32 v26, 128, v24
    v_xor_b32 v27, 192, v24
    v_lshlrev_b32 v7, 1, v6
    v_xor_b32 v7, v7, v5
    v_lshl_add_u32 v28, v7, 4, v4
    v_add_u32 v29, 6144, v28
    v_add_u32 v30, 12288, v28
    v_add_u32 v31, 18432, v28
    s_branch L_sched
L_issX0:
    s_mov_b32 m0, s52
    s_waitcnt vmcnt(59)
    buffer_load_dwordx4 v8, s[28:31], s53 offen offset:0  lds
    buffer_load_dwordx4 v9, s[28:31], s53 offen offset:1024  lds
    buffer_load_dwordx4 v10, s[28:31], s53 offen offset:2048  lds
    buffer_load_dwordx4 v11, s[28:31], s53 offen offset:3072  lds
L_issX1:
    s_add_u32 m0, s52, 4096
    s_add_u32 s53, s53, 28672
    s_waitcnt vmcnt(59)
    buffer_load_dwordx4 v8, s[28:31], s53 offen offset:0  lds
    buffer_load_dwordx4 v9, s[28:31], s53 offen offset:1024  lds
    buffer_load_dwordx4 v10, s[28:31], s53 offen offset:2048  lds
    buffer_load_dwordx4 v11, s[28:31], s53 offen offset:3072  lds
L_issX2:
    s_add_u32 m0, s52, 8192
    s_add_u32 s53, s53, 28672
    s_waitcnt vmcnt(59)
    buffer_load_dwordx4 v8, s[28:31], s53 offen offset:0  lds
    buffer_load_dwordx4 v9, s[28:31], s53 offen offset:1024  lds
    buffer_load_dwordx4 v10, s[28:31], s53 offen offset:2048  lds
    buffer_load_dwordx4 v11, s[28:31], s53 offen offset:3072  lds
L_issX_ret:
    s_setpc_b64 s[56:57]
L_issW0:
    s_mov_b32 m0, s52
    s_waitcnt vmcnt(59)
    buffer_load_dwordx4 v32, s[32:35], s53 offen offset:0  lds
    buffer_load_dwordx4 v33, s[32:35], s53 offen offset:1024  lds
    buffer_load_dwordx4 v34, s[32:35], s53 offen offset:2048  lds
    buffer_load_dwordx4 v35, s[32:35], s53 offen offset:3072  lds
L_issW1:
    s_add_u32 m0, s52, 4096
    s_add_u32 s53, s53, 65536
    s_waitcnt vmcnt(59)
    buffer_load_dwordx4 v36, s[32:35], s53 offen offset:0  lds
    buffer_load_dwordx4 v37, s[32:35], s53 offen offset:1024  lds
    buffer_load_dwordx4 v38, s[32:35], s53 offen offset:2048  lds
    buffer_load_dwordx4 v39, s[32:35], s53 offen offset:3072  lds
L_issW2:
    s_add_u32 m0, s52, 8192
    s_add_u32 s53, s53, 65536
    s_waitcnt vmcnt(59)
    buffer_load_dwordx4 v32, s[32:35], s53 offen offset:0  lds
    buffer_load_dwordx4 v33, s[32:35], s53 offen offset:1024  lds
    buffer_load_dwordx4 v34, s[32:35], s53 offen offset:2048  lds
    buffer_load_dwordx4 v35, s[32:35], s53 offen offset:3072  lds
L_issW3:
    s_add_u32 m0, s52, 12288
    s_add_u32 s53, s53, 65536
    s_waitcnt vmcnt(59)
    buffer_load_dwordx4 v36, s[32:35], s53 offen offset:0  lds
    buffer_load_dwordx4 v37, s[32:35], s53 offen offset:1024  lds
    buffer_load_dwordx4 v38, s[32:35], s53 offen offset:2048  lds
    buffer_load_dwordx4 v39, s[32:35], s53 offen offset:3072  lds
L_issW_ret:
    s_setpc_b64 s[56:57]
L_issK0:
    s_mov_b32 m0, s52
    s_waitcnt vmcnt(59)
    buffer_load_dwordx4 v16, s[36:39], s53 offen offset:0 nt lds
    buffer_load_dwordx4 v17, s[36:39], s53 offen offset:1024 nt lds
    buffer_load_dwordx4 v18, s[36:39], s53 offen offset:2048 nt lds
    buffer_load_dwordx4 v19, s[36:39], s53 offen offset:3072 nt lds
    s_cmp_eq_u32 s91, 0
    s_cbranch_scc1 L_issK_ret
L_issK1:
    s_add_u32 m0, s52, 4096
    s_add_u32 s53, s53, 4096
    s_waitcnt vmcnt(59)
    buffer_load_dwordx4 v20, s[36:39], s53 offen offset:0 nt lds
    buffer_load_dwordx4 v21, s[36:39], s53 offen offset:1024 nt lds
    buffer_load_dwordx4 v22, s[36:39], s53 offen offset:2048 nt lds
    buffer_load_dwordx4 v23, s[36:39], s53 offen offset:3072 nt lds
    s_cmp_eq_u32 s91, 1
    s_cbranch_scc1 L_issK_ret
L_issK2:
    s_add_u32 m0, s52, 8192
    s_add_u32 s53, s53, 4096
    s_waitcnt vmcnt(59)
    buffer_load_dwordx4 v16, s[36:39], s53 offen offset:0 nt lds
    buffer_load_dwordx4 v17, s[36:39], s53 offen offset:1024 nt lds
    buffer_load_dwordx4 v18, s[36:39], s53 offen offset:2048 nt lds
    buffer_load_dwordx4 v19, s[36:39], s53 offen offset:3072 nt lds
    s_cmp_eq_u32 s91, 2
    s_cbranch_scc1 L_issK_ret
L_issK3:
    s_add_u32 m0, s52, 12288
    s_add_u32 s53, s53, 4096
    s_waitcnt vmcnt(59)
    buffer_load_dwordx4 v20, s[36:39], s53 offen offset:0 nt lds
    buffer_load_dwordx4 v21, s[36:39], s53 offen offset:1024 nt lds
    buffer_load_dwordx4 v22, s[36:39], s53 offen offset:2048 nt lds
    buffer_load_dwordx4 v23, s[36:39], s53 offen offset:3072 nt lds
L_issK_ret:
    s_setpc_b64 s[56:57]
L_issV0:
    s_mov_b32 m0, s52
    s_waitcnt vmcnt(59)
    buffer_load_dwordx4 v24, s[40:43], s53 offen offset:0 nt lds
    buffer_load_dwordx4 v25, s[40:43], s53 offen offset:1024 nt lds
    buffer_load_dwordx4 v26, s[40:43], s53 offen offset:2048 nt lds
    buffer_load_dwordx4 v27, s[40:43], s53 offen offset:3072 nt lds
    s_cmp_eq_u32 s91, 0
    s_cbranch_scc1 L_issV_ret
L_issV1:
    s_add_u32 m0, s52, 4096
    s_add_u32 s53, s53, 4096
    s_waitcnt vmcnt(59)
    buffer_load_dwordx4 v24, s[40:43], s53 offen offset:0 nt lds
    buffer_load_dwordx4 v25, s[40:43], s53 offen offset:1024 nt lds
    buffer_load_dwordx4 v26, s[40:43], s53 offen offset:2048 nt lds
    buffer_load_dwordx4 v27, s[40:43], s53 offen offset:3072 nt lds
    s_cmp_eq_u32 s91, 1
    s_cbranch_scc1 L_issV_ret
L_issV2:
    s_add_u32 m0, s52, 8192
    s_add_u32 s53, s53, 4096
    s_waitcnt vmcnt(59)
    buffer_load_dwordx4 v24, s[40:43], s53 offen offset:0 nt lds
    buffer_load_dwordx4 v25, s[40:43], s53 offen offset:1024 nt lds
    buffer_load_dwordx4 v26, s[40:43], s53 offen offset:2048 nt lds
    buffer_load_dwordx4 v27, s[40:43], s53 offen offset:3072 nt lds
    s_cmp_eq_u32 s91, 2
    s_cbranch_scc1 L_issV_ret
L_issV3:
    s_add_u32 m0, s52, 12288
    s_add_u32 s53, s53, 4096
    s_waitcnt vmcnt(59)
    buffer_load_dwordx4 v24, s[40:43], s53 offen offset:0 nt lds
    buffer_load_dwordx4 v25, s[40:43], s53 offen offset:1024 nt lds
    buffer_load_dwordx4 v26, s[40:43], s53 offen offset:2048 nt lds
    buffer_load_dwordx4 v27, s[40:43], s53 offen offset:3072 nt lds
L_issV_ret:
    s_setpc_b64 s[56:57]
L_issO0:
    s_mov_b32 m0, s52
    s_waitcnt vmcnt(59)
    buffer_load_dwordx4 v28, s[44:47], s53 offen offset:0  lds
    buffer_load_dwordx4 v29, s[44:47], s53 offen offset:1024  lds
    buffer_load_dwordx4 v30, s[44:47], s53 offen offset:2048  lds
    buffer_load_dwordx4 v31, s[44:47], s53 offen offset:3072  lds
    s_cmp_eq_u32 s91, 0
    s_cbranch_scc1 L_issO_ret
L_issO1:
    s_add_u32 m0, s52, 4096
    s_add_u32 s53, s53, 28672
    s_waitcnt vmcnt(59)
    buffer_load_dwordx4 v28, s[44:47], s53 offen offset:0  lds
    buffer_load_dwordx4 v29, s[44:47], s53 offen offset:1024  lds
    buffer_load_dwordx4 v30, s[44:47], s53 offen offset:2048  lds
    buffer_load_dwordx4 v31, s[44:47], s53 offen offset:3072  lds
    s_cmp_eq_u32 s91, 1
    s_cbranch_scc1 L_issO_ret
L_issO2:
    s_add_u32 m0, s52, 8192
    s_add_u32 s53, s53, 28672
    s_waitcnt vmcnt(59)
    buffer_load_dwordx4 v28, s[44:47], s53 offen offset:0  lds
    buffer_load_dwordx4 v29, s[44:47], s53 offen offset:1024  lds
    buffer_load_dwordx4 v30, s[44:47], s53 offen offset:2048  lds
    buffer_load_dwordx4 v31, s[44:47], s53 offen offset:3072  lds
    s_cmp_eq_u32 s91, 2
    s_cbranch_scc1 L_issO_ret
L_issO3:
    s_add_u32 m0, s52, 12288
    s_add_u32 s53, s53, 28672
    s_waitcnt vmcnt(59)
    buffer_load_dwordx4 v28, s[44:47], s53 offen offset:0  lds
    buffer_load_dwordx4 v29, s[44:47], s53 offen offset:1024  lds
    buffer_load_dwordx4 v30, s[44:47], s53 offen offset:2048  lds
    buffer_load_dwordx4 v31, s[44:47], s53 offen offset:3072  lds
L_issO_ret:
    s_setpc_b64 s[56:57]
L_sched:
    s_mov_b32 s52, 98304
    s_lshl_b32 s53, s58, 7
    s_call_b64 s[56:57], L_issX0
    s_mov_b32 s52, 114688
    s_lshl_b32 s53, s58, 19
    s_call_b64 s[56:57], L_issW0
    s_waitcnt vmcnt(44)
    s_barrier
    s_mov_b32 s86, s22
    s_mov_b32 s52, 131072
    s_lshl_b32 s53, s58, 19
    s_add_u32 s53, s53, 262144
    s_add_u32 s58, s58, 1
    s_cmp_eq_u32 s58, 7
    s_cselect_b32 s58, 0, s58
    s_call_b64 s[56:57], L_issW0
    s_mov_b32 s52, 147456
    s_lshl_b32 s53, s58, 7
    s_call_b64 s[56:57], L_issX0
    s_waitcnt vmcnt(56)
    s_barrier
    s_waitcnt vmcnt(28)
    s_barrier
    s_mov_b32 s52, 49152
    s_lshl_b32 s53, s58, 19
    s_call_b64 s[56:57], L_issW0
    s_mov_b32 s52, 65536
    s_lshl_b32 s53, s58, 19
    s_add_u32 s53, s53, 262144
    s_add_u32 s58, s58, 1
    s_cmp_eq_u32 s58, 7
    s_cselect_b32 s58, 0, s58
    s_call_b64 s[56:57], L_issW0
    s_waitcnt vmcnt(44)
    s_barrier
    s_mov_b32 s52, 81920
    s_lshl_b32 s53, s58, 7
    s_call_b64 s[56:57], L_issX0
    s_mov_b32 s52, 0
    s_add_u32 s53, s63, 0
    s_and_b32 s53, s53, 0x7ffff
    s_mov_b32 s91, 3
    s_call_b64 s[56:57], L_issK0
    s_waitcnt vmcnt(44)
    s_barrier
    s_mov_b32 s52, 98304
    s_lshl_b32 s53, s58, 19
    s_call_b64 s[56:57], L_issW0
    s_mov_b32 s52, 114688
    s_lshl_b32 s53, s58, 19
    s_add_u32 s53, s53, 262144
    s_add_u32 s58, s58, 1
    s_cmp_eq_u32 s58, 7
    s_cselect_b32 s58, 0, s58
    s_call_b64 s[56:57], L_issW0
    s_waitcnt vmcnt(60)
    s_barrier
    s_mov_b32 s52, 131072
    s_lshl_b32 s53, s58, 7
    s_call_b64 s[56:57], L_issX0
    s_mov_b32 s52, 16384
    s_add_u32 s53, s63, 16384
    s_and_b32 s53, s53, 0x7ffff
    s_call_b64 s[56:57], L_issK0
    s_waitcnt vmcnt(44)
    s_barrier
    s_mov_b32 s52, 147456
    s_lshl_b32 s53, s58, 19
    s_call_b64 s[56:57], L_issW0
    s_mov_b32 s52, 49152
    s_lshl_b32 s53, s58, 19
    s_add_u32 s53, s53, 262144
    s_add_u32 s58, s58, 1
    s_cmp_eq_u32 s58, 7
    s_cselect_b32 s58, 0, s58
    s_call_b64 s[56:57], L_issW0
    s_waitcnt vmcnt(60)
    s_barrier
    s_mov_b32 s52, 65536
    s_lshl_b32 s53, s58, 7
    s_call_b64 s[56:57], L_issX0
    s_mov_b32 s52, 32768
    s_add_u32 s53, s63, 0
    s_and_b32 s53, s53, 0x7ffff
    s_call_b64 s[56:57], L_issV0
    s_waitcnt vmcnt(44)
    s_barrier
    s_mov_b32 s52, 81920
    s_lshl_b32 s53, s58, 19
    s_call_b64 s[56:57], L_issW0
    s_mov_b32 s52, 98304
    s_lshl_b32 s53, s58, 19
    s_add_u32 s53, s53, 262144
    s_add_u32 s58, s58, 1
    s_cmp_eq_u32 s58, 7
    s_cselect_b32 s58, 0, s58
    s_call_b64 s[56:57], L_issW0
    s_waitcnt vmcnt(60)
    s_barrier
    s_mov_b32 s52, 114688
    s_lshl_b32 s53, s58, 7
    s_call_b64 s[56:57], L_issX0
    s_waitcnt vmcnt(28)
    s_barrier
    s_mov_b32 s52, 131072
    s_lshl_b32 s53, s58, 19
    s_call_b64 s[56:57], L_issW0
    s_mov_b32 s52, 147456
    s_lshl_b32 s53, s58, 19
    s_add_u32 s53, s53, 262144
    s_add_u32 s58, s58, 1
    s_cmp_eq_u32 s58, 7
    s_cselect_b32 s58, 0, s58
    s_call_b64 s[56:57], L_issW0
    s_waitcnt vmcnt(44)
    s_barrier
    s_mov_b32 s52, 49152
    s_add_u32 s53, s63, 32768
    s_and_b32 s53, s53, 0x7ffff
    s_call_b64 s[56:57], L_issK0
    s_waitcnt vmcnt(32)
    s_barrier
    s_mov_b32 s52, 65536
    s_add_u32 s53, s63, 16384
    s_and_b32 s53, s53, 0x7ffff
    s_call_b64 s[56:57], L_issV0
    s_waitcnt vmcnt(32)
    s_barrier
    s_mov_b32 s52, 81920
    s_add_u32 s53, s63, 49152
    s_and_b32 s53, s53, 0x7ffff
    s_call_b64 s[56:57], L_issK0
    s_mov_b32 s52, 98304
    s_add_u32 s53, s63, 32768
    s_and_b32 s53, s53, 0x7ffff
    s_mov_b32 s91, 0
    s_call_b64 s[56:57], L_issV0
    s_barrier
    s_call_b64 s[56:57], L_issV1
    s_mov_b32 s52, 114688
    s_add_u32 s53, s63, 65536
    s_and_b32 s53, s53, 0x7ffff
    s_mov_b32 s91, 2
    s_call_b64 s[56:57], L_issK0
    s_mov_b64 exec, 0
    s_branch L_pg4
L_w2_0:
    s_mov_b64 exec, -1
    s_barrier
    s_call_b64 s[56:57], L_issK3
    s_mov_b32 s52, 131072
    s_add_u32 s53, s63, 49152
    s_and_b32 s53, s53, 0x7ffff
    s_mov_b32 s91, 3
    s_call_b64 s[56:57], L_issV0
    s_barrier
    s_mov_b32 s52, 147456
    s_add_u32 s53, s63, 81920
    s_and_b32 s53, s53, 0x7ffff
    s_call_b64 s[56:57], L_issK0
    s_barrier
    s_mov_b32 s52, 0
    s_add_u32 s53, s63, 65536
    s_and_b32 s53, s53, 0x7ffff
    s_call_b64 s[56:57], L_issV0
    s_barrier
    s_mov_b32 s52, 16384
    s_add_u32 s53, s63, 98304
    s_and_b32 s53, s53, 0x7ffff
    s_call_b64 s[56:57], L_issK0
    s_barrier
    s_mov_b32 s52, 32768
    s_add_u32 s53, s63, 81920
    s_and_b32 s53, s53, 0x7ffff
    s_call_b64 s[56:57], L_issV0
    s_barrier
    s_mov_b32 s52, 49152
    s_add_u32 s53, s63, 114688
    s_and_b32 s53, s53, 0x7ffff
    s_call_b64 s[56:57], L_issK0
    s_barrier
    s_mov_b32 s52, 65536
    s_add_u32 s53, s63, 98304
    s_and_b32 s53, s53, 0x7ffff
    s_call_b64 s[56:57], L_issV0
    s_barrier
    s_mov_b32 s52, 81920
    s_add_u32 s53, s63, 131072
    s_and_b32 s53, s53, 0x7ffff
    s_call_b64 s[56:57], L_issK0
    s_barrier
    s_mov_b32 s52, 98304
    s_add_u32 s53, s63, 114688
    s_and_b32 s53, s53, 0x7ffff
    s_mov_b32 s91, 2
    s_call_b64 s[56:57], L_issV0
    s_barrier
    s_call_b64 s[56:57], L_issV3
    s_mov_b32 s52, 114688
    s_add_u32 s53, s63, 147456
    s_and_b32 s53, s53, 0x7ffff
    s_call_b64 s[56:57], L_issK0
L_pg0:
    s_cbranch_execz L_warm_done
    s_mov_b64 exec, 0
    s_branch L_pg5
L_w2_1:
    s_mov_b64 exec, -1
    s_barrier
    s_call_b64 s[56:57], L_issK3
    s_mov_b32 s52, 131072
    s_add_u32 s53, s63, 131072
    s_and_b32 s53, s53, 0x7ffff
    s_mov_b32 s91, 1
    s_call_b64 s[56:57], L_issV0
    s_barrier
    s_call_b64 s[56:57], L_issV2
    s_mov_b32 s52, 147456
    s_add_u32 s53, s63, 163840
    s_and_b32 s53, s53, 0x7ffff
    s_call_b64 s[56:57], L_issK0
    s_barrier
    s_call_b64 s[56:57], L_issK2
    s_mov_b32 s52, 0
    s_add_u32 s53, s63, 147456
    s_and_b32 s53, s53, 0x7ffff
    s_mov_b32 s91, 0
    s_call_b64 s[56:57], L_issV0
    s_barrier
    s_call_b64 s[56:57], L_issV1
    s_mov_b32 s52, 16384
    s_add_u32 s53, s63, 180224
    s_and_b32 s53, s53, 0x7ffff
    s_call_b64 s[56:57], L_issK0
    s_barrier
    s_call_b64 s[56:57], L_issK1
    s_barrier
    s_mov_b32 s52, 32768
    s_add_u32 s53, s63, 163840
    s_and_b32 s53, s53, 0x7ffff
    s_mov_b32 s91, 3
    s_call_b64 s[56:57], L_issV0
    s_barrier
    s_mov_b32 s52, 49152
    s_add_u32 s53, s63, 196608
    s_and_b32 s53, s53, 0x7ffff
    s_mov_b32 s91, 2
    s_call_b64 s[56:57], L_issK0
    s_barrier
    s_call_b64 s[56:57], L_issK3
    s_mov_b32 s52, 65536
    s_add_u32 s53, s63, 180224
    s_and_b32 s53, s53, 0x7ffff
    s_call_b64 s[56:57], L_issV0
    s_mov_b64 exec, 0
    s_branch L_pg6
L_w2_2:
    s_mov_b64 exec, -1
    s_barrier
    s_call_b64 s[56:57], L_issV3
    s_mov_b32 s52, 81920
    s_add_u32 s53, s63, 212992
    s_and_b32 s53, s53, 0x7ffff
    s_mov_b32 s91, 1
    s_call_b64 s[56:57], L_issK0
    s_barrier
    s_call_b64 s[56:57], L_issK2
    s_mov_b32 s52, 98304
    s_add_u32 s53, s63, 196608
    s_and_b32 s53, s53, 0x7ffff
    s_call_b64 s[56:57], L_issV0
    s_barrier
    s_call_b64 s[56:57], L_issV2
    s_mov_b32 s52, 114688
    s_add_u32 s53, s63, 229376
    s_and_b32 s53, s53, 0x7ffff
    s_call_b64 s[56:57], L_issK0
    s_barrier
    s_call_b64 s[56:57], L_issK2
    s_mov_b32 s52, 131072
    s_add_u32 s53, s63, 212992
    s_and_b32 s53, s53, 0x7ffff
    s_mov_b32 s91, 0
    s_call_b64 s[56:57], L_issV0
    s_barrier
    s_call_b64 s[56:57], L_issV1
    s_mov_b32 s52, 147456
    s_add_u32 s53, s63, 245760
    s_and_b32 s53, s53, 0x7ffff
    s_call_b64 s[56:57], L_issK0
    s_barrier
    s_call_b64 s[56:57], L_issK1
    s_barrier
    s_mov_b32 s52, 0
    s_add_u32 s53, s63, 229376
    s_and_b32 s53, s53, 0x7ffff
    s_mov_b32 s91, 3
    s_call_b64 s[56:57], L_issV0
    s_barrier
    s_lshl_b32 s54, s69, 4
    v_mov_b32 v40, s54
    s_waitcnt vmcnt(59)
    global_load_dword v41, v40, s[16:17] sc1
    s_mov_b32 s52, 16384
    s_add_u32 s53, s63, 262144
    s_and_b32 s53, s53, 0x7ffff
    s_call_b64 s[56:57], L_issK0
    s_mov_b64 exec, 0
    s_branch L_pg7
L_w2_3:
    s_mov_b64 exec, -1
    s_barrier
    s_mov_b32 s52, 32768
    s_add_u32 s53, s63, 245760
    s_and_b32 s53, s53, 0x7ffff
    s_mov_b32 s91, 2
    s_call_b64 s[56:57], L_issV0
    s_waitcnt vmcnt(61)
    s_barrier
    s_call_b64 s[56:57], L_issV3
    s_mov_b32 s52, 49152
    s_add_u32 s53, s63, 278528
    s_and_b32 s53, s53, 0x7ffff
    s_call_b64 s[56:57], L_issK0
    s_waitcnt vmcnt(61)
    s_barrier
    s_call_b64 s[56:57], L_issK3
    s_mov_b32 s52, 65536
    s_add_u32 s53, s63, 262144
    s_and_b32 s53, s53, 0x7ffff
    s_mov_b32 s91, 1
    s_call_b64 s[56:57], L_issV0
    s_waitcnt vmcnt(57)
    s_barrier
    s_call_b64 s[56:57], L_issV2
    s_mov_b32 s52, 81920
    s_add_u32 s53, s63, 294912
    s_and_b32 s53, s53, 0x7ffff
    s_call_b64 s[56:57], L_issK0
    s_waitcnt vmcnt(56)
    s_barrier
    s_call_b64 s[56:57], L_issK2
    s_mov_b32 s52, 98304
    s_add_u32 s53, s63, 278528
    s_and_b32 s53, s53, 0x7ffff
    s_call_b64 s[56:57], L_issV0
    s_waitcnt vmcnt(56)
    s_barrier
    s_call_b64 s[56:57], L_issV2
    s_mov_b32 s52, 114688
    s_add_u32 s53, s63, 311296
    s_and_b32 s53, s53, 0x7ffff
    s_mov_b32 s91, 0
    s_call_b64 s[56:57], L_issK0
    s_waitcnt vmcnt(52)
    s_barrier
    s_call_b64 s[56:57], L_issK1
    s_mov_b32 s52, 131072
    s_add_u32 s53, s63, 294912
    s_and_b32 s53, s53, 0x7ffff
    s_call_b64 s[56:57], L_issV0
    s_waitcnt vmcnt(52)
    s_barrier
    s_call_b64 s[56:57], L_issV1
    s_mov_b32 s52, 147456
    s_add_u32 s53, s63, 327680
    s_and_b32 s53, s53, 0x7ffff
    s_call_b64 s[56:57], L_issK0
    s_mov_b64 exec, 0
    s_branch L_pg8
L_w2_4:
    s_mov_b64 exec, -1
    s_waitcnt vmcnt(52)
    s_barrier
    s_call_b64 s[56:57], L_issK1
    s_waitcnt vmcnt(48)
    s_barrier
    s_mov_b32 s52, 0
    s_add_u32 s53, s63, 311296
    s_and_b32 s53, s53, 0x7ffff
    s_mov_b32 s91, 3
    s_call_b64 s[56:57], L_issV0
    s_waitcnt vmcnt(48)
    s_barrier
    s_mov_b32 s52, 16384
    s_add_u32 s53, s63, 344064
    s_and_b32 s53, s53, 0x7ffff
    s_call_b64 s[56:57], L_issK0
    s_mov_b32 s55, 1048576
L_spin0:
    v_cmp_gt_u32 vcc, 16, v41
    s_cbranch_vccz L_spin0_done
    global_load_dword v41, v40, s[16:17] sc1
    s_waitcnt vmcnt(0)
    s_sub_u32 s55, s55, 1
    s_cbranch_scc0 L_spin0
L_spin0_done:
    s_waitcnt vmcnt(48)
    s_barrier
    s_mov_b32 s52, 32768
    s_add_u32 s53, s63, 327680
    s_and_b32 s53, s53, 0x7ffff
    s_call_b64 s[56:57], L_issV0
    s_waitcnt vmcnt(48)
    s_barrier
    s_mov_b32 s52, 49152
    s_add_u32 s53, s63, 360448
    s_and_b32 s53, s53, 0x7ffff
    s_mov_b32 s91, 2
    s_call_b64 s[56:57], L_issK0
    s_waitcnt vmcnt(44)
    s_barrier
    s_call_b64 s[56:57], L_issK3
    s_mov_b32 s52, 65536
    s_add_u32 s53, s63, 344064
    s_and_b32 s53, s53, 0x7ffff
    s_call_b64 s[56:57], L_issV0
    s_waitcnt vmcnt(44)
    s_barrier
    s_call_b64 s[56:57], L_issV3
    s_mov_b32 s52, 81920
    s_add_u32 s53, s63, 376832
    s_and_b32 s53, s53, 0x7ffff
    s_call_b64 s[56:57], L_issK0
    s_waitcnt vmcnt(44)
    s_barrier
    s_call_b64 s[56:57], L_issK3
    s_mov_b32 s52, 98304
    s_add_u32 s53, s63, 360448
    s_and_b32 s53, s53, 0x7ffff
    s_mov_b32 s91, 1
    s_call_b64 s[56:57], L_issV0
    s_waitcnt vmcnt(40)
    s_barrier
    s_call_b64 s[56:57], L_issV2
    s_mov_b32 s52, 114688
    s_add_u32 s53, s63, 393216
    s_and_b32 s53, s53, 0x7ffff
    s_call_b64 s[56:57], L_issK0
    s_waitcnt vmcnt(40)
    s_barrier
    s_call_b64 s[56:57], L_issK2
    s_mov_b32 s52, 131072
    s_add_u32 s53, s63, 376832
    s_and_b32 s53, s53, 0x7ffff
    s_call_b64 s[56:57], L_issV0
    s_waitcnt vmcnt(40)
    s_barrier
    s_call_b64 s[56:57], L_issV2
    s_mov_b32 s52, 147456
    s_add_u32 s53, s63, 409600
    s_and_b32 s53, s53, 0x7ffff
    s_call_b64 s[56:57], L_issK0
    s_waitcnt vmcnt(40)
    s_barrier
    s_call_b64 s[56:57], L_issK2
    s_mov_b32 s52, 0
    s_add_u32 s53, s63, 393216
    s_and_b32 s53, s53, 0x7ffff
    s_mov_b32 s91, 0
    s_call_b64 s[56:57], L_issV0
    s_waitcnt vmcnt(36)
    s_barrier
    s_call_b64 s[56:57], L_issV1
    s_mov_b32 s52, 16384
    s_add_u32 s53, s63, 425984
    s_and_b32 s53, s53, 0x7ffff
    s_call_b64 s[56:57], L_issK0
    s_waitcnt vmcnt(36)
    s_barrier
    s_call_b64 s[56:57], L_issK1
    s_mov_b32 s52, 32768
    s_add_u32 s53, s63, 409600
    s_and_b32 s53, s53, 0x7ffff
    s_call_b64 s[56:57], L_issV0
    s_waitcnt vmcnt(36)
    s_barrier
    s_call_b64 s[56:57], L_issV1
    s_mov_b32 s52, 49152
    s_add_u32 s53, s63, 442368
    s_and_b32 s53, s53, 0x7ffff
    s_call_b64 s[56:57], L_issK0
    s_waitcnt vmcnt(36)
    s_barrier
    s_call_b64 s[56:57], L_issK1
    s_mov_b32 s52, 65536
    s_add_u32 s53, s63, 425984
    s_and_b32 s53, s53, 0x7ffff
    s_call_b64 s[56:57], L_issV0
    s_waitcnt vmcnt(36)
    s_barrier
    s_call_b64 s[56:57], L_issV1
    s_waitcnt vmcnt(32)
    s_barrier
    s_mov_b32 s52, 81920
    s_add_u32 s53, s63, 458752
    s_and_b32 s53, s53, 0x7ffff
    s_mov_b32 s91, 3
    s_call_b64 s[56:57], L_issK0
    s_waitcnt vmcnt(32)
    s_barrier
    s_mov_b32 s52, 98304
    s_add_u32 s53, s63, 442368
    s_and_b32 s53, s53, 0x7ffff
    s_call_b64 s[56:57], L_issV0
    s_waitcnt vmcnt(32)
    s_barrier
    s_mov_b32 s86, 0
    s_mov_b32 s52, 114688
    s_add_u32 s53, s63, 475136
    s_and_b32 s53, s53, 0x7ffff
    s_call_b64 s[56:57], L_issK0
    s_waitcnt vmcnt(32)
    s_barrier
    s_mov_b32 s52, 131072
    s_add_u32 s53, s63, 458752
    s_and_b32 s53, s53, 0x7ffff
    s_call_b64 s[56:57], L_issV0
    s_waitcnt vmcnt(32)
    s_barrier
    s_mov_b32 s52, 147456
    s_add_u32 s53, s63, 491520
    s_and_b32 s53, s53, 0x7ffff
    s_call_b64 s[56:57], L_issK0
    s_waitcnt vmcnt(32)
    s_barrier
    s_mov_b32 s52, 0
    s_add_u32 s53, s63, 475136
    s_and_b32 s53, s53, 0x7ffff
    s_call_b64 s[56:57], L_issV0
    s_waitcnt vmcnt(32)
    s_barrier
    s_mov_b32 s52, 16384
    s_add_u32 s53, s63, 507904
    s_and_b32 s53, s53, 0x7ffff
    s_call_b64 s[56:57], L_issK0
    s_waitcnt vmcnt(32)
    s_barrier
    s_mov_b32 s52, 32768
    s_add_u32 s53, s63, 491520
    s_and_b32 s53, s53, 0x7ffff
    s_call_b64 s[56:57], L_issV0
    s_waitcnt vmcnt(32)
    s_barrier
    s_mov_b32 s52, 49152
    s_add_u32 s53, s63, 507904
    s_and_b32 s53, s53, 0x7ffff
    s_call_b64 s[56:57], L_issV0
    s_waitcnt vmcnt(32)
    s_barrier
    s_mov_b32 s52, 65536
    s_lshl_b32 s53, s59, 7
    s_call_b64 s[56:57], L_issO0
    s_waitcnt vmcnt(32)
    s_barrier
    s_mov_b32 s52, 81920
    s_lshl_b32 s53, s59, 7
    s_add_u32 s53, s53, 114688
    s_add_u32 s59, s59, 1
    s_cmp_eq_u32 s59, 7
    s_cselect_b32 s59, 0, s59
    s_call_b64 s[56:57], L_issO0
    s_waitcnt vmcnt(32)
    s_barrier
    s_mov_b32 s52, 98304
    s_lshl_b32 s53, s59, 7
    s_call_b64 s[56:57], L_issO0
    s_mov_b32 s52, 114688
    s_lshl_b32 s53, s59, 7
    s_add_u32 s53, s53, 114688
    s_add_u32 s59, s59, 1
    s_cmp_eq_u32 s59, 7
    s_cselect_b32 s59, 0, s59
    s_call_b64 s[56:57], L_issO0
    s_mov_b32 s52, 131072
    s_lshl_b32 s53, s59, 7
    s_call_b64 s[56:57], L_issO0
    s_barrier
    s_mov_b32 s52, 147456
    s_lshl_b32 s53, s59, 7
    s_add_u32 s53, s53, 114688
    s_add_u32 s59, s59, 1
    s_cmp_eq_u32 s59, 7
    s_cselect_b32 s59, 0, s59
    s_call_b64 s[56:57], L_issO0
    s_mov_b32 s52, 0
    s_lshl_b32 s53, s59, 7
    s_call_b64 s[56:57], L_issO0
    s_mov_b32 s52, 16384
    s_lshl_b32 s53, s59, 7
    s_add_u32 s53, s53, 114688
    s_add_u32 s59, s59, 1
    s_cmp_eq_u32 s59, 7
    s_cselect_b32 s59, 0, s59
    s_call_b64 s[56:57], L_issO0
    s_barrier
    s_mov_b32 s52, 32768
    s_lshl_b32 s53, s59, 7
    s_call_b64 s[56:57], L_issO0
    s_mov_b32 s52, 49152
    s_lshl_b32 s53, s59, 7
    s_add_u32 s53, s53, 114688
    s_add_u32 s59, s59, 1
    s_cmp_eq_u32 s59, 7
    s_cselect_b32 s59, 0, s59
    s_call_b64 s[56:57], L_issO0
    s_barrier
    s_mov_b32 s52, 65536
    s_lshl_b32 s53, s59, 7
    s_call_b64 s[56:57], L_issO0
    s_barrier
    s_mov_b32 s52, 81920
    s_lshl_b32 s53, s59, 7
    s_add_u32 s53, s53, 114688
    s_add_u32 s59, s59, 1
    s_cmp_eq_u32 s59, 7
    s_cselect_b32 s59, 0, s59
    s_call_b64 s[56:57], L_issO0
    s_mov_b32 s52, 98304
    s_lshl_b32 s53, s59, 7
    s_call_b64 s[56:57], L_issO0
    s_waitcnt vmcnt(48)
    s_barrier
    s_mov_b32 s52, 114688
    s_lshl_b32 s53, s59, 7
    s_add_u32 s53, s53, 114688
    s_add_u32 s59, s59, 1
    s_cmp_eq_u32 s59, 7
    s_cselect_b32 s59, 0, s59
    s_call_b64 s[56:57], L_issO0
    s_waitcnt vmcnt(0)
    s_barrier
    s_branch L_tail
L_exit0:
    s_endpgm
L_compute:
    s_getpc_b64 s[30:31]
L_pc:
    s_sub_u32 s30, s30, L_pc-L_code0
    s_subb_u32 s31, s31, 0
    s_lshr_b32 s54, s2, 3
    s_mul_i32 s54, s54, 3
    s_add_u32 s54, s54, s27
    s_sub_u32 s54, s54, 1
    s_lshl_b32 s54, s54, 9
    v_and_b32 v2, 3, v1
    v_lshl_add_u32 v2, v2, 7, s54
    v_min_u32 v2, L_code1-L_code0-4, v2
    global_load_dword v20, v2, s[30:31]
    s_mov_b64 exec, 0
    s_cmp_eq_u32 s27, 1
    s_cbranch_scc1 L_pg1
    s_cmp_eq_u32 s27, 2
    s_cbranch_scc1 L_pg2
    s_cmp_eq_u32 s27, 3
    s_cbranch_scc1 L_pg3
L_warm_done:
    s_mov_b64 exec, -1
    v_lshrrev_b32 v2, 4, v1
    v_and_b32 v3, 15, v1
    v_xor_b32 v4, v2, v3
    v_lshlrev_b32 v4, 4, v4
    v_lshl_add_u32 v4, v3, 9, v4
    v_accvgpr_write_b32 a80, v4
    v_lshrrev_b32 v4, 2, v1
    v_and_b32 v5, 31, v1
    v_lshlrev_b32 v5, 3, v5
    v_lshl_add_u32 v7, v4, 9, v5
    v_accvgpr_write_b32 a81, v7
    v_lshl_add_u32 v16, v2, 11, v7
    v_bfe_u32 v5, v1, 3, 2
    v_and_b32 v6, 3, v1
    v_lshlrev_b32 v6, 3, v6
    v_lshl_add_u32 v5, v5, 5, v6
    v_lshl_add_u32 v5, v4, 7, v5
    v_accvgpr_write_b32 a82, v5
    s_sub_u32 s55, s27, 1
    s_lshl_b32 s68, s55, 12
    v_lshrrev_b32 v8, 1, v3
    v_xor_b32 v8, v8, v2
    v_lshlrev_b32 v8, 4, v8
    v_lshl_add_u32 v8, v3, 7, v8
    v_add_u32 v17, s68, v8
    v_mov_b32 v60, 0
    v_mov_b32 v61, 0
    s_mov_b32 s60, 0x3db8aa3b
    s_mov_b32 s61, 0x43800000
    s_mov_b32 s88, s60
    s_mov_b32 s89, s60
    s_cmp_eq_u32 s24, 7
    s_cselect_b32 s67, 0, s24
    s_mul_i32 s67, s67, 12288
    s_add_u32 s67, s67, s68
    s_add_u32 s66, s68, 86016
    s_mul_i32 s54, s69, 1376256
    s_mul_i32 s53, s25, 86016
    s_add_u32 s54, s54, s53
    s_mul_i32 s53, s69, 3072
    s_add_u32 s53, s53, 25165824
    s_lshl_b32 s52, s25, 2
    s_add_u32 s53, s53, s52
    s_mul_i32 s52, s55, 1024
    s_add_u32 s53, s53, s52
    s_waitcnt lgkmcnt(0)
    s_add_u32 s48, s14, s54
    s_addc_u32 s49, s15, 0
    s_mov_b32 s50, 86016
    s_mov_b32 s51, 0x20000
    s_add_u32 s44, s14, s53
    s_addc_u32 s45, s15, 0
    s_mov_b32 s46, 3072
    s_mov_b32 s47, 0x20000
    s_cmp_eq_u32 s27, 1
    s_cbranch_scc0 L_noinit
    v_mul_u32_u24 v2, 256, v1
    v_mov_b32 v3, 0
    buffer_store_dword v3, v2, s[44:47], 0 offen sc1
L_noinit:
    v_mov_b32 v52, 0
    v_mov_b32 v53, 0
    v_mov_b32 v54, 0
    v_mov_b32 v55, 0
    v_mov_b32 v56, 0
    v_mov_b32 v57, 0
    v_mov_b32 v58, 0
    v_mov_b32 v59, 0
    s_mov_b32 s46, 1024
    s_lshl_b32 s54, s69, 4
    v_lshlrev_b32 v18, 2, v1
    v_mov_b32 v19, 1
    s_add_u32 s40, s16, s54
    s_addc_u32 s41, s17, 0
    s_mov_b32 s42, 4
    s_mov_b32 s43, 0x20000
    v_add_u32 v40, 49152, v17
    v_xor_b32 v41, 64, v40
    v_add_u32 v44, 65536, v16
    v_xor_b32 v45, 32, v44
    v_xor_b32 v46, 64, v44
    v_xor_b32 v47, 96, v44
    v_xor_b32 v48, 128, v44
    v_xor_b32 v49, 160, v44
    v_xor_b32 v50, 192, v44
    v_xor_b32 v51, 224, v44
    s_barrier
    ds_read_b128 a[64:67], v40 offset:0
    ds_read_b128 a[68:71], v40 offset:2048
    ds_read_b64_tr_b16 a[0:1], v44 offset:0
    ds_read_b64_tr_b16 a[2:3], v44 offset:2048
    ds_read_b64_tr_b16 a[4:5], v45 offset:0
    ds_read_b64_tr_b16 a[6:7], v45 offset:2048
    ds_read_b64_tr_b16 a[8:9], v46 offset:0
    ds_read_b64_tr_b16 a[10:11], v46 offset:2048
    ds_read_b64_tr_b16 a[12:13], v47 offset:0
    ds_read_b64_tr_b16 a[14:15], v47 offset:2048
    ds_read_b64_tr_b16 a[16:17], v48 offset:0
    ds_read_b64_tr_b16 a[18:19], v48 offset:2048
    ds_read_b64_tr_b16 a[20:21], v49 offset:0
    ds_read_b64_tr_b16 a[22:23], v49 offset:2048
    s_waitcnt lgkmcnt(12)
    s_waitcnt lgkmcnt(8)
    v_mfma_f32_16x16x32_bf16 v[128:131], a[0:3], a[64:67], 0
    ds_read_b64_tr_b16 a[24:25], v50 offset:0
    ds_read_b64_tr_b16 a[26:27], v50 offset:2048
    v_mfma_f32_16x16x32_bf16 v[136:139], a[0:3], a[68:71], 0
    ds_read_b128 a[72:75], v41 offset:0
    v_mfma_f32_16x16x32_bf16 v[132:135], a[4:7], a[64:67], 0
    ds_read_b64_tr_b16 a[28:29], v51 offset:0
    ds_read_b64_tr_b16 a[30:31], v51 offset:2048
    v_mfma_f32_16x16x32_bf16 v[140:143], a[4:7], a[68:71], 0
    s_waitcnt lgkmcnt(9)
    v_mfma_f32_16x16x32_bf16 v[144:147], a[8:11], a[64:67], 0
    ds_read_b64_tr_b16 a[32:33], v44 offset:256
    ds_read_b64_tr_b16 a[34:35], v44 offset:2304
    v_mfma_f32_16x16x32_bf16 v[152:155], a[8:11], a[68:71], 0
    ds_read_b128 a[76:79], v41 offset:2048
    v_add_u32 v44, 81920, v16
    v_mfma_f32_16x16x32_bf16 v[148:151], a[12:15], a[64:67], 0
    ds_read_b64_tr_b16 a[36:37], v45 offset:256
    ds_read_b64_tr_b16 a[38:39], v45 offset:2304
    v_mfma_f32_16x16x32_bf16 v[156:159], a[12:15], a[68:71], 0
    s_waitcnt lgkmcnt(10)
    v_xor_b32 v45, 32, v44
    v_mfma_f32_16x16x32_bf16 v[160:163], a[16:19], a[64:67], 0
    ds_read_b64_tr_b16 a[40:41], v46 offset:256
    ds_read_b64_tr_b16 a[42:43], v46 offset:2304
    v_mfma_f32_16x16x32_bf16 v[168:171], a[16:19], a[68:71], 0
    v_xor_b32 v46, 64, v44
    v_mfma_f32_16x16x32_bf16 v[164:167], a[20:23], a[64:67], 0
    ds_read_b64_tr_b16 a[44:45], v47 offset:256
    ds_read_b64_tr_b16 a[46:47], v47 offset:2304
    v_mfma_f32_16x16x32_bf16 v[172:175], a[20:23], a[68:71], 0
    s_waitcnt lgkmcnt(9)
    v_xor_b32 v47, 96, v44
    v_mfma_f32_16x16x32_bf16 v[176:179], a[24:27], a[64:67], 0
    ds_read_b64_tr_b16 a[48:49], v48 offset:256
    ds_read_b64_tr_b16 a[50:51], v48 offset:2304
    v_mfma_f32_16x16x32_bf16 v[184:187], a[24:27], a[68:71], 0
    v_xor_b32 v48, 128, v44
    v_mfma_f32_16x16x32_bf16 v[180:183], a[28:31], a[64:67], 0
    ds_read_b64_tr_b16 a[52:53], v49 offset:256
    ds_read_b64_tr_b16 a[54:55], v49 offset:2304
    v_mfma_f32_16x16x32_bf16 v[188:191], a[28:31], a[68:71], 0
    s_waitcnt lgkmcnt(8)
    v_xor_b32 v49, 160, v44
    v_mfma_f32_16x16x32_bf16 v[192:195], a[32:35], a[64:67], 0
    ds_read_b64_tr_b16 a[56:57], v50 offset:256
    ds_read_b64_tr_b16 a[58:59], v50 offset:2304
    v_mfma_f32_16x16x32_bf16 v[200:203], a[32:35], a[68:71], 0
    v_xor_b32 v50, 192, v44
    v_mfma_f32_16x16x32_bf16 v[196:199], a[36:39], a[64:67], 0
    ds_read_b64_tr_b16 a[60:61], v51 offset:256
    ds_read_b64_tr_b16 a[62:63], v51 offset:2304
    v_mfma_f32_16x16x32_bf16 v[204:207], a[36:39], a[68:71], 0
    s_waitcnt lgkmcnt(8)
    v_xor_b32 v51, 224, v44
    v_mfma_f32_16x16x32_bf16 v[208:211], a[40:43], a[64:67], 0
    s_barrier
    ds_read_b64_tr_b16 a[0:1], v44 offset:0
    ds_read_b64_tr_b16 a[2:3], v44 offset:2048
    v_mfma_f32_16x16x32_bf16 v[216:219], a[40:43], a[68:71], 0
    v_mfma_f32_16x16x32_bf16 v[212:215], a[44:47], a[64:67], 0
    ds_read_b64_tr_b16 a[4:5], v45 offset:0
    ds_read_b64_tr_b16 a[6:7], v45 offset:2048
    v_mfma_f32_16x16x32_bf16 v[220:223], a[44:47], a[68:71], 0
    s_waitcnt lgkmcnt(8)
    v_mfma_f32_16x16x32_bf16 v[224:227], a[48:51], a[64:67], 0
    ds_read_b64_tr_b16 a[8:9], v46 offset:0
    ds_read_b64_tr_b16 a[10:11], v46 offset:2048
    v_mfma_f32_16x16x32_bf16 v[232:235], a[48:51], a[68:71], 0
    v_mfma_f32_16x16x32_bf16 v[228:231], a[52:55], a[64:67], 0
    ds_read_b64_tr_b16 a[12:13], v47 offset:0
    ds_read_b64_tr_b16 a[14:15], v47 offset:2048
    v_mfma_f32_16x16x32_bf16 v[236:239], a[52:55], a[68:71], 0
    s_waitcnt lgkmcnt(8)
    v_mfma_f32_16x16x32_bf16 v[240:243], a[56:59], a[64:67], 0
    ds_read_b64_tr_b16 a[16:17], v48 offset:0
    ds_read_b64_tr_b16 a[18:19], v48 offset:2048
    v_mfma_f32_16x16x32_bf16 v[248:251], a[56:59], a[68:71], 0
    v_mfma_f32_16x16x32_bf16 v[244:247], a[60:63], a[64:67], 0
    ds_read_b64_tr_b16 a[20:21], v49 offset:0
    ds_read_b64_tr_b16 a[22:23], v49 offset:2048
    v_mfma_f32_16x16x32_bf16 v[252:255], a[60:63], a[68:71], 0
    s_waitcnt lgkmcnt(8)
    v_mfma_f32_16x16x32_bf16 v[128:131], a[0:3], a[72:75], v[128:131]
    ds_read_b64_tr_b16 a[24:25], v50 offset:0
    ds_read_b64_tr_b16 a[26:27], v50 offset:2048
    v_mfma_f32_16x16x32_bf16 v[136:139], a[0:3], a[76:79], v[136:139]
    v_add_u32 v40, 98304, v17
    v_xor_b32 v41, 64, v40
    v_mfma_f32_16x16x32_bf16 v[132:135], a[4:7], a[72:75], v[132:135]
    ds_read_b64_tr_b16 a[28:29], v51 offset:0
    ds_read_b64_tr_b16 a[30:31], v51 offset:2048
    v_mfma_f32_16x16x32_bf16 v[140:143], a[4:7], a[76:79], v[140:143]
    s_waitcnt lgkmcnt(8)
    v_mfma_f32_16x16x32_bf16 v[144:147], a[8:11], a[72:75], v[144:147]
    ds_read_b64_tr_b16 a[32:33], v44 offset:256
    ds_read_b64_tr_b16 a[34:35], v44 offset:2304
    v_mfma_f32_16x16x32_bf16 v[152:155], a[8:11], a[76:79], v[152:155]
    v_add_u32 v44, 114688, v16
    v_mfma_f32_16x16x32_bf16 v[148:151], a[12:15], a[72:75], v[148:151]
    ds_read_b64_tr_b16 a[36:37], v45 offset:256
    ds_read_b64_tr_b16 a[38:39], v45 offset:2304
    v_mfma_f32_16x16x32_bf16 v[156:159], a[12:15], a[76:79], v[156:159]
    s_waitcnt lgkmcnt(8)
    v_xor_b32 v45, 32, v44
    v_mfma_f32_16x16x32_bf16 v[160:163], a[16:19], a[72:75], v[160:163]
    ds_read_b64_tr_b16 a[40:41], v46 offset:256
    ds_read_b64_tr_b16 a[42:43], v46 offset:2304
    v_mfma_f32_16x16x32_bf16 v[168:171], a[16:19], a[76:79], v[168:171]
    v_xor_b32 v46, 64, v44
    v_mfma_f32_16x16x32_bf16 v[164:167], a[20:23], a[72:75], v[164:167]
    ds_read_b64_tr_b16 a[44:45], v47 offset:256
    ds_read_b64_tr_b16 a[46:47], v47 offset:2304
    v_mfma_f32_16x16x32_bf16 v[172:175], a[20:23], a[76:79], v[172:175]
    s_waitcnt lgkmcnt(8)
    v_xor_b32 v47, 96, v44
    v_mfma_f32_16x16x32_bf16 v[176:179], a[24:27], a[72:75], v[176:179]
    ds_read_b64_tr_b16 a[48:49], v48 offset:256
    ds_read_b64_tr_b16 a[50:51], v48 offset:2304
    v_mfma_f32_16x16x32_bf16 v[184:187], a[24:27], a[76:79], v[184:187]
    v_xor_b32 v48, 128, v44
    v_mfma_f32_16x16x32_bf16 v[180:183], a[28:31], a[72:75], v[180:183]
    ds_read_b64_tr_b16 a[52:53], v49 offset:256
    ds_read_b64_tr_b16 a[54:55], v49 offset:2304
    v_mfma_f32_16x16x32_bf16 v[188:191], a[28:31], a[76:79], v[188:191]
    s_waitcnt lgkmcnt(8)
    v_xor_b32 v49, 160, v44
    v_mfma_f32_16x16x32_bf16 v[192:195], a[32:35], a[72:75], v[192:195]
    ds_read_b64_tr_b16 a[56:57], v50 offset:256
    ds_read_b64_tr_b16 a[58:59], v50 offset:2304
    v_mfma_f32_16x16x32_bf16 v[200:203], a[32:35], a[76:79], v[200:203]
    v_xor_b32 v50, 192, v44
    v_mfma_f32_16x16x32_bf16 v[196:199], a[36:39], a[72:75], v[196:199]
    ds_read_b64_tr_b16 a[60:61], v51 offset:256
    ds_read_b64_tr_b16 a[62:63], v51 offset:2304
    v_mfma_f32_16x16x32_bf16 v[204:207], a[36:39], a[76:79], v[204:207]
    s_waitcnt lgkmcnt(8)
    v_xor_b32 v51, 224, v44
    v_mfma_f32_16x16x32_bf16 v[208:211], a[40:43], a[72:75], v[208:211]
    s_barrier
    ds_read_b64_tr_b16 a[0:1], v44 offset:0
    ds_read_b64_tr_b16 a[2:3], v44 offset:2048
    v_mfma_f32_16x16x32_bf16 v[216:219], a[40:43], a[76:79], v[216:219]
    ds_read_b128 a[64:67], v40 offset:0
    v_mfma_f32_16x16x32_bf16 v[212:215], a[44:47], a[72:75], v[212:215]
L_pg1:
    s_cbranch_execz L_warm_done
    ds_read_b64_tr_b16 a[4:5], v45 offset:0
    ds_read_b64_tr_b16 a[6:7], v45 offset:2048
    v_mfma_f32_16x16x32_bf16 v[220:223], a[44:47], a[76:79], v[220:223]
    s_waitcnt lgkmcnt(9)
    ds_read_b128 a[68:71], v40 offset:2048
    v_mfma_f32_16x16x32_bf16 v[224:227], a[48:51], a[72:75], v[224:227]
    ds_read_b64_tr_b16 a[8:9], v46 offset:0
    ds_read_b64_tr_b16 a[10:11], v46 offset:2048
    v_mfma_f32_16x16x32_bf16 v[232:235], a[48:51], a[76:79], v[232:235]
    v_mfma_f32_16x16x32_bf16 v[228:231], a[52:55], a[72:75], v[228:231]
    ds_read_b64_tr_b16 a[12:13], v47 offset:0
    ds_read_b64_tr_b16 a[14:15], v47 offset:2048
    v_mfma_f32_16x16x32_bf16 v[236:239], a[52:55], a[76:79], v[236:239]
    s_waitcnt lgkmcnt(10)
    v_mfma_f32_16x16x32_bf16 v[240:243], a[56:59], a[72:75], v[240:243]
    ds_read_b64_tr_b16 a[16:17], v48 offset:0
    ds_read_b64_tr_b16 a[18:19], v48 offset:2048
    v_mfma_f32_16x16x32_bf16 v[248:251], a[56:59], a[76:79], v[248:251]
    v_mfma_f32_16x16x32_bf16 v[244:247], a[60:63], a[72:75], v[244:247]
    ds_read_b64_tr_b16 a[20:21], v49 offset:0
    ds_read_b64_tr_b16 a[22:23], v49 offset:2048
    v_mfma_f32_16x16x32_bf16 v[252:255], a[60:63], a[76:79], v[252:255]
    s_waitcnt lgkmcnt(8)
    v_mfma_f32_16x16x32_bf16 v[128:131], a[0:3], a[64:67], v[128:131]
    ds_read_b64_tr_b16 a[24:25], v50 offset:0
    ds_read_b64_tr_b16 a[26:27], v50 offset:2048
    v_mfma_f32_16x16x32_bf16 v[136:139], a[0:3], a[68:71], v[136:139]
    ds_read_b128 a[72:75], v41 offset:0
    v_mfma_f32_16x16x32_bf16 v[132:135], a[4:7], a[64:67], v[132:135]
    ds_read_b64_tr_b16 a[28:29], v51 offset:0
    ds_read_b64_tr_b16 a[30:31], v51 offset:2048
    v_mfma_f32_16x16x32_bf16 v[140:143], a[4:7], a[68:71], v[140:143]
    s_waitcnt lgkmcnt(9)
    v_mfma_f32_16x16x32_bf16 v[144:147], a[8:11], a[64:67], v[144:147]
    ds_read_b64_tr_b16 a[32:33], v44 offset:256
    ds_read_b64_tr_b16 a[34:35], v44 offset:2304
    v_mfma_f32_16x16x32_bf16 v[152:155], a[8:11], a[68:71], v[152:155]
    ds_read_b128 a[76:79], v41 offset:2048
    v_add_u32 v44, 131072, v16
    v_mfma_f32_16x16x32_bf16 v[148:151], a[12:15], a[64:67], v[148:151]
    ds_read_b64_tr_b16 a[36:37], v45 offset:256
    ds_read_b64_tr_b16 a[38:39], v45 offset:2304
    v_mfma_f32_16x16x32_bf16 v[156:159], a[12:15], a[68:71], v[156:159]
    s_waitcnt lgkmcnt(10)
    v_xor_b32 v45, 32, v44
    v_mfma_f32_16x16x32_bf16 v[160:163], a[16:19], a[64:67], v[160:163]
    ds_read_b64_tr_b16 a[40:41], v46 offset:256
    ds_read_b64_tr_b16 a[42:43], v46 offset:2304
    v_mfma_f32_16x16x32_bf16 v[168:171], a[16:19], a[68:71], v[168:171]
    v_xor_b32 v46, 64, v44
    v_mfma_f32_16x16x32_bf16 v[164:167], a[20:23], a[64:67], v[164:167]
    ds_read_b64_tr_b16 a[44:45], v47 offset:256
    ds_read_b64_tr_b16 a[46:47], v47 offset:2304
    v_mfma_f32_16x16x32_bf16 v[172:175], a[20:23], a[68:71], v[172:175]
    s_waitcnt lgkmcnt(9)
    v_xor_b32 v47, 96, v44
    v_mfma_f32_16x16x32_bf16 v[176:179], a[24:27], a[64:67], v[176:179]
    ds_read_b64_tr_b16 a[48:49], v48 offset:256
    ds_read_b64_tr_b16 a[50:51], v48 offset:2304
    v_mfma_f32_16x16x32_bf16 v[184:187], a[24:27], a[68:71], v[184:187]
    v_xor_b32 v48, 128, v44
    v_mfma_f32_16x16x32_bf16 v[180:183], a[28:31], a[64:67], v[180:183]
    ds_read_b64_tr_b16 a[52:53], v49 offset:256
    ds_read_b64_tr_b16 a[54:55], v49 offset:2304
    v_mfma_f32_16x16x32_bf16 v[188:191], a[28:31], a[68:71], v[188:191]
    s_waitcnt lgkmcnt(8)
    v_xor_b32 v49, 160, v44
    v_mfma_f32_16x16x32_bf16 v[192:195], a[32:35], a[64:67], v[192:195]
    ds_read_b64_tr_b16 a[56:57], v50 offset:256
    ds_read_b64_tr_b16 a[58:59], v50 offset:2304
    v_mfma_f32_16x16x32_bf16 v[200:203], a[32:35], a[68:71], v[200:203]
    v_xor_b32 v50, 192, v44
    v_mfma_f32_16x16x32_bf16 v[196:199], a[36:39], a[64:67], v[196:199]
    ds_read_b64_tr_b16 a[60:61], v51 offset:256
    ds_read_b64_tr_b16 a[62:63], v51 offset:2304
    v_mfma_f32_16x16x32_bf16 v[204:207], a[36:39], a[68:71], v[204:207]
    s_waitcnt lgkmcnt(8)
    v_xor_b32 v51, 224, v44
    v_mfma_f32_16x16x32_bf16 v[208:211], a[40:43], a[64:67], v[208:211]
    s_barrier
    ds_read_b64_tr_b16 a[0:1], v44 offset:0
    ds_read_b64_tr_b16 a[2:3], v44 offset:2048
    v_mfma_f32_16x16x32_bf16 v[216:219], a[40:43], a[68:71], v[216:219]
    v_mfma_f32_16x16x32_bf16 v[212:215], a[44:47], a[64:67], v[212:215]
    ds_read_b64_tr_b16 a[4:5], v45 offset:0
    ds_read_b64_tr_b16 a[6:7], v45 offset:2048
    v_mfma_f32_16x16x32_bf16 v[220:223], a[44:47], a[68:71], v[220:223]
    s_waitcnt lgkmcnt(8)
    v_mfma_f32_16x16x32_bf16 v[224:227], a[48:51], a[64:67], v[224:227]
    ds_read_b64_tr_b16 a[8:9], v46 offset:0
    ds_read_b64_tr_b16 a[10:11], v46 offset:2048
    v_mfma_f32_16x16x32_bf16 v[232:235], a[48:51], a[68:71], v[232:235]
    v_mfma_f32_16x16x32_bf16 v[228:231], a[52:55], a[64:67], v[228:231]
    ds_read_b64_tr_b16 a[12:13], v47 offset:0
    ds_read_b64_tr_b16 a[14:15], v47 offset:2048
    v_mfma_f32_16x16x32_bf16 v[236:239], a[52:55], a[68:71], v[236:239]
    s_waitcnt lgkmcnt(8)
    v_mfma_f32_16x16x32_bf16 v[240:243], a[56:59], a[64:67], v[240:243]
    ds_read_b64_tr_b16 a[16:17], v48 offset:0
    ds_read_b64_tr_b16 a[18:19], v48 offset:2048
    v_mfma_f32_16x16x32_bf16 v[248:251], a[56:59], a[68:71], v[248:251]
    v_mfma_f32_16x16x32_bf16 v[244:247], a[60:63], a[64:67], v[244:247]
    ds_read_b64_tr_b16 a[20:21], v49 offset:0
    ds_read_b64_tr_b16 a[22:23], v49 offset:2048
    v_mfma_f32_16x16x32_bf16 v[252:255], a[60:63], a[68:71], v[252:255]
    s_waitcnt lgkmcnt(8)
    v_mfma_f32_16x16x32_bf16 v[128:131], a[0:3], a[72:75], v[128:131]
    ds_read_b64_tr_b16 a[24:25], v50 offset:0
    ds_read_b64_tr_b16 a[26:27], v50 offset:2048
    v_mfma_f32_16x16x32_bf16 v[136:139], a[0:3], a[76:79], v[136:139]
    v_add_u32 v40, 147456, v17
    v_xor_b32 v41, 64, v40
    v_mfma_f32_16x16x32_bf16 v[132:135], a[4:7], a[72:75], v[132:135]
    ds_read_b64_tr_b16 a[28:29], v51 offset:0
    ds_read_b64_tr_b16 a[30:31], v51 offset:2048
    v_mfma_f32_16x16x32_bf16 v[140:143], a[4:7], a[76:79], v[140:143]
    s_waitcnt lgkmcnt(8)
    v_mfma_f32_16x16x32_bf16 v[144:147], a[8:11], a[72:75], v[144:147]
    ds_read_b64_tr_b16 a[32:33], v44 offset:256
    ds_read_b64_tr_b16 a[34:35], v44 offset:2304
    v_mfma_f32_16x16x32_bf16 v[152:155], a[8:11], a[76:79], v[152:155]
    v_add_u32 v44, 49152, v16
    v_mfma_f32_16x16x32_bf16 v[148:151], a[12:15], a[72:75], v[148:151]
    ds_read_b64_tr_b16 a[36:37], v45 offset:256
    ds_read_b64_tr_b16 a[38:39], v45 offset:2304
    v_mfma_f32_16x16x32_bf16 v[156:159], a[12:15], a[76:79], v[156:159]
    s_waitcnt lgkmcnt(8)
    v_xor_b32 v45, 32, v44
    v_mfma_f32_16x16x32_bf16 v[160:163], a[16:19], a[72:75], v[160:163]
    ds_read_b64_tr_b16 a[40:41], v46 offset:256
    ds_read_b64_tr_b16 a[42:43], v46 offset:2304
    v_mfma_f32_16x16x32_bf16 v[168:171], a[16:19], a[76:79], v[168:171]
    v_xor_b32 v46, 64, v44
    v_mfma_f32_16x16x32_bf16 v[164:167], a[20:23], a[72:75], v[164:167]
    ds_read_b64_tr_b16 a[44:45], v47 offset:256
    ds_read_b64_tr_b16 a[46:47], v47 offset:2304
    v_mfma_f32_16x16x32_bf16 v[172:175], a[20:23], a[76:79], v[172:175]
    s_waitcnt lgkmcnt(8)
    v_xor_b32 v47, 96, v44
    v_mfma_f32_16x16x32_bf16 v[176:179], a[24:27], a[72:75], v[176:179]
    ds_read_b64_tr_b16 a[48:49], v48 offset:256
    ds_read_b64_tr_b16 a[50:51], v48 offset:2304
    v_mfma_f32_16x16x32_bf16 v[184:187], a[24:27], a[76:79], v[184:187]
    v_xor_b32 v48, 128, v44
    v_mfma_f32_16x16x32_bf16 v[180:183], a[28:31], a[72:75], v[180:183]
    ds_read_b64_tr_b16 a[52:53], v49 offset:256
    ds_read_b64_tr_b16 a[54:55], v49 offset:2304
    v_mfma_f32_16x16x32_bf16 v[188:191], a[28:31], a[76:79], v[188:191]
    s_waitcnt lgkmcnt(8)
    v_xor_b32 v49, 160, v44
    v_mfma_f32_16x16x32_bf16 v[192:195], a[32:35], a[72:75], v[192:195]
    ds_read_b64_tr_b16 a[56:57], v50 offset:256
    ds_read_b64_tr_b16 a[58:59], v50 offset:2304
    v_mfma_f32_16x16x32_bf16 v[200:203], a[32:35], a[76:79], v[200:203]
    v_xor_b32 v50, 192, v44
    v_mfma_f32_16x16x32_bf16 v[196:199], a[36:39], a[72:75], v[196:199]
    ds_read_b64_tr_b16 a[60:61], v51 offset:256
    ds_read_b64_tr_b16 a[62:63], v51 offset:2304
    v_mfma_f32_16x16x32_bf16 v[204:207], a[36:39], a[76:79], v[204:207]
    s_waitcnt lgkmcnt(8)
    v_xor_b32 v51, 224, v44
    v_mfma_f32_16x16x32_bf16 v[208:211], a[40:43], a[72:75], v[208:211]
    s_barrier
    ds_read_b64_tr_b16 a[0:1], v44 offset:0
    ds_read_b64_tr_b16 a[2:3], v44 offset:2048
    v_mfma_f32_16x16x32_bf16 v[216:219], a[40:43], a[76:79], v[216:219]
    ds_read_b128 a[64:67], v40 offset:0
    v_mfma_f32_16x16x32_bf16 v[212:215], a[44:47], a[72:75], v[212:215]
    ds_read_b64_tr_b16 a[4:5], v45 offset:0
    ds_read_b64_tr_b16 a[6:7], v45 offset:2048
    v_mfma_f32_16x16x32_bf16 v[220:223], a[44:47], a[76:79], v[220:223]
    s_waitcnt lgkmcnt(9)
    ds_read_b128 a[68:71], v40 offset:2048
    v_mfma_f32_16x16x32_bf16 v[224:227], a[48:51], a[72:75], v[224:227]
    ds_read_b64_tr_b16 a[8:9], v46 offset:0
    ds_read_b64_tr_b16 a[10:11], v46 offset:2048
    v_mfma_f32_16x16x32_bf16 v[232:235], a[48:51], a[76:79], v[232:235]
    v_mfma_f32_16x16x32_bf16 v[228:231], a[52:55], a[72:75], v[228:231]
    ds_read_b64_tr_b16 a[12:13], v47 offset:0
    ds_read_b64_tr_b16 a[14:15], v47 offset:2048
    v_mfma_f32_16x16x32_bf16 v[236:239], a[52:55], a[76:79], v[236:239]
    s_waitcnt lgkmcnt(10)
    v_mfma_f32_16x16x32_bf16 v[240:243], a[56:59], a[72:75], v[240:243]
    ds_read_b64_tr_b16 a[16:17], v48 offset:0
    ds_read_b64_tr_b16 a[18:19], v48 offset:2048
    v_mfma_f32_16x16x32_bf16 v[248:251], a[56:59], a[76:79], v[248:251]
    v_mfma_f32_16x16x32_bf16 v[244:247], a[60:63], a[72:75], v[244:247]
    ds_read_b64_tr_b16 a[20:21], v49 offset:0
    ds_read_b64_tr_b16 a[22:23], v49 offset:2048
    v_mfma_f32_16x16x32_bf16 v[252:255], a[60:63], a[76:79], v[252:255]
    s_waitcnt lgkmcnt(8)
    v_mfma_f32_16x16x32_bf16 v[128:131], a[0:3], a[64:67], v[128:131]
    ds_read_b64_tr_b16 a[24:25], v50 offset:0
    ds_read_b64_tr_b16 a[26:27], v50 offset:2048
    v_mfma_f32_16x16x32_bf16 v[136:139], a[0:3], a[68:71], v[136:139]
    ds_read_b128 a[72:75], v41 offset:0
    v_mfma_f32_16x16x32_bf16 v[132:135], a[4:7], a[64:67], v[132:135]
    ds_read_b64_tr_b16 a[28:29], v51 offset:0
    ds_read_b64_tr_b16 a[30:31], v51 offset:2048
    v_mfma_f32_16x16x32_bf16 v[140:143], a[4:7], a[68:71], v[140:143]
    s_waitcnt lgkmcnt(9)
    v_mfma_f32_16x16x32_bf16 v[144:147], a[8:11], a[64:67], v[144:147]
    ds_read_b64_tr_b16 a[32:33], v44 offset:256
    ds_read_b64_tr_b16 a[34:35], v44 offset:2304
    v_mfma_f32_16x16x32_bf16 v[152:155], a[8:11], a[68:71], v[152:155]
    ds_read_b128 a[76:79], v41 offset:2048
    v_add_u32 v44, 65536, v16
    v_mfma_f32_16x16x32_bf16 v[148:151], a[12:15], a[64:67], v[148:151]
    ds_read_b64_tr_b16 a[36:37], v45 offset:256
    ds_read_b64_tr_b16 a[38:39], v45 offset:2304
    v_mfma_f32_16x16x32_bf16 v[156:159], a[12:15], a[68:71], v[156:159]
    s_waitcnt lgkmcnt(10)
    v_xor_b32 v45, 32, v44
    v_mfma_f32_16x16x32_bf16 v[160:163], a[16:19], a[64:67], v[160:163]
    ds_read_b64_tr_b16 a[40:41], v46 offset:256
    ds_read_b64_tr_b16 a[42:43], v46 offset:2304
    v_mfma_f32_16x16x32_bf16 v[168:171], a[16:19], a[68:71], v[168:171]
    v_xor_b32 v46, 64, v44
    v_mfma_f32_16x16x32_bf16 v[164:167], a[20:23], a[64:67], v[164:167]
    ds_read_b64_tr_b16 a[44:45], v47 offset:256
    ds_read_b64_tr_b16 a[46:47], v47 offset:2304
    v_mfma_f32_16x16x32_bf16 v[172:175], a[20:23], a[68:71], v[172:175]
    s_waitcnt lgkmcnt(9)
    v_xor_b32 v47, 96, v44
    v_mfma_f32_16x16x32_bf16 v[176:179], a[24:27], a[64:67], v[176:179]
    ds_read_b64_tr_b16 a[48:49], v48 offset:256
    ds_read_b64_tr_b16 a[50:51], v48 offset:2304
    v_mfma_f32_16x16x32_bf16 v[184:187], a[24:27], a[68:71], v[184:187]
    v_xor_b32 v48, 128, v44
    v_mfma_f32_16x16x32_bf16 v[180:183], a[28:31], a[64:67], v[180:183]
    ds_read_b64_tr_b16 a[52:53], v49 offset:256
    ds_read_b64_tr_b16 a[54:55], v49 offset:2304
    v_mfma_f32_16x16x32_bf16 v[188:191], a[28:31], a[68:71], v[188:191]
    s_waitcnt lgkmcnt(8)
    v_xor_b32 v49, 160, v44
    v_mfma_f32_16x16x32_bf16 v[192:195], a[32:35], a[64:67], v[192:195]
    ds_read_b64_tr_b16 a[56:57], v50 offset:256
    ds_read_b64_tr_b16 a[58:59], v50 offset:2304
    v_mfma_f32_16x16x32_bf16 v[200:203], a[32:35], a[68:71], v[200:203]
    v_xor_b32 v50, 192, v44
    v_mfma_f32_16x16x32_bf16 v[196:199], a[36:39], a[64:67], v[196:199]
    ds_read_b64_tr_b16 a[60:61], v51 offset:256
    ds_read_b64_tr_b16 a[62:63], v51 offset:2304
    v_mfma_f32_16x16x32_bf16 v[204:207], a[36:39], a[68:71], v[204:207]
    s_waitcnt lgkmcnt(8)
    v_xor_b32 v51, 224, v44
    v_mfma_f32_16x16x32_bf16 v[208:211], a[40:43], a[64:67], v[208:211]
    s_barrier
    ds_read_b64_tr_b16 a[0:1], v44 offset:0
    ds_read_b64_tr_b16 a[2:3], v44 offset:2048
    v_mfma_f32_16x16x32_bf16 v[216:219], a[40:43], a[68:71], v[216:219]
    v_mfma_f32_16x16x32_bf16 v[212:215], a[44:47], a[64:67], v[212:215]
    ds_read_b64_tr_b16 a[4:5], v45 offset:0
    ds_read_b64_tr_b16 a[6:7], v45 offset:2048
    v_mfma_f32_16x16x32_bf16 v[220:223], a[44:47], a[68:71], v[220:223]
    s_waitcnt lgkmcnt(8)
    v_mfma_f32_16x16x32_bf16 v[224:227], a[48:51], a[64:67], v[224:227]
    ds_read_b64_tr_b16 a[8:9], v46 offset:0
    ds_read_b64_tr_b16 a[10:11], v46 offset:2048
    v_mfma_f32_16x16x32_bf16 v[232:235], a[48:51], a[68:71], v[232:235]
    v_mfma_f32_16x16x32_bf16 v[228:231], a[52:55], a[64:67], v[228:231]
    ds_read_b64_tr_b16 a[12:13], v47 offset:0
    ds_read_b64_tr_b16 a[14:15], v47 offset:2048
    v_mfma_f32_16x16x32_bf16 v[236:239], a[52:55], a[68:71], v[236:239]
    s_waitcnt lgkmcnt(8)
    v_mfma_f32_16x16x32_bf16 v[240:243], a[56:59], a[64:67], v[240:243]
    ds_read_b64_tr_b16 a[16:17], v48 offset:0
    ds_read_b64_tr_b16 a[18:19], v48 offset:2048
    v_mfma_f32_16x16x32_bf16 v[248:251], a[56:59], a[68:71], v[248:251]
    s_waitcnt vmcnt(0)
    s_cmp_eq_u32 s27, 1
    s_cbranch_scc0 L_noinit2
    buffer_atomic_add v19, v18, s[40:43], 0 offen sc1
L_noinit2:
    v_mfma_f32_16x16x32_bf16 v[244:247], a[60:63], a[64:67], v[244:247]
    ds_read_b64_tr_b16 a[20:21], v49 offset:0
    ds_read_b64_tr_b16 a[22:23], v49 offset:2048
    v_mfma_f32_16x16x32_bf16 v[252:255], a[60:63], a[68:71], v[252:255]
    s_waitcnt lgkmcnt(8)
    v_mfma_f32_16x16x32_bf16 v[128:131], a[0:3], a[72:75], v[128:131]
    ds_read_b64_tr_b16 a[24:25], v50 offset:0
    ds_read_b64_tr_b16 a[26:27], v50 offset:2048
    v_mfma_f32_16x16x32_bf16 v[136:139], a[0:3], a[76:79], v[136:139]
    v_add_u32 v40, 81920, v17
    v_xor_b32 v41, 64, v40
    v_mfma_f32_16x16x32_bf16 v[132:135], a[4:7], a[72:75], v[132:135]
    ds_read_b64_tr_b16 a[28:29], v51 offset:0
    ds_read_b64_tr_b16 a[30:31], v51 offset:2048
    v_mfma_f32_16x16x32_bf16 v[140:143], a[4:7], a[76:79], v[140:143]
    s_waitcnt lgkmcnt(8)
    v_mfma_f32_16x16x32_bf16 v[144:147], a[8:11], a[72:75], v[144:147]
    ds_read_b64_tr_b16 a[32:33], v44 offset:256
    ds_read_b64_tr_b16 a[34:35], v44 offset:2304
    v_mfma_f32_16x16x32_bf16 v[152:155], a[8:11], a[76:79], v[152:155]
    v_add_u32 v44, 98304, v16
    v_mfma_f32_16x16x32_bf16 v[148:151], a[12:15], a[72:75], v[148:151]
    ds_read_b64_tr_b16 a[36:37], v45 offset:256
    ds_read_b64_tr_b16 a[38:39], v45 offset:2304
    v_mfma_f32_16x16x32_bf16 v[156:159], a[12:15], a[76:79], v[156:159]
    s_waitcnt lgkmcnt(8)
    v_xor_b32 v45, 32, v44
    v_mfma_f32_16x16x32_bf16 v[160:163], a[16:19], a[72:75], v[160:163]
    ds_read_b64_tr_b16 a[40:41], v46 offset:256
    ds_read_b64_tr_b16 a[42:43], v46 offset:2304
    v_mfma_f32_16x16x32_bf16 v[168:171], a[16:19], a[76:79], v[168:171]
    v_xor_b32 v46, 64, v44
    v_mfma_f32_16x16x32_bf16 v[164:167], a[20:23], a[72:75], v[164:167]
    ds_read_b64_tr_b16 a[44:45], v47 offset:256
    ds_read_b64_tr_b16 a[46:47], v47 offset:2304
    v_mfma_f32_16x16x32_bf16 v[172:175], a[20:23], a[76:79], v[172:175]
    s_waitcnt lgkmcnt(8)
    v_xor_b32 v47, 96, v44
    v_mfma_f32_16x16x32_bf16 v[176:179], a[24:27], a[72:75], v[176:179]
    ds_read_b64_tr_b16 a[48:49], v48 offset:256
    ds_read_b64_tr_b16 a[50:51], v48 offset:2304
    v_mfma_f32_16x16x32_bf16 v[184:187], a[24:27], a[76:79], v[184:187]
    v_xor_b32 v48, 128, v44
    v_mfma_f32_16x16x32_bf16 v[180:183], a[28:31], a[72:75], v[180:183]
    ds_read_b64_tr_b16 a[52:53], v49 offset:256
    ds_read_b64_tr_b16 a[54:55], v49 offset:2304
    v_mfma_f32_16x16x32_bf16 v[188:191], a[28:31], a[76:79], v[188:191]
    s_waitcnt lgkmcnt(8)
    v_xor_b32 v49, 160, v44
    v_mfma_f32_16x16x32_bf16 v[192:195], a[32:35], a[72:75], v[192:195]
    ds_read_b64_tr_b16 a[56:57], v50 offset:256
    ds_read_b64_tr_b16 a[58:59], v50 offset:2304
    v_mfma_f32_16x16x32_bf16 v[200:203], a[32:35], a[76:79], v[200:203]
    v_xor_b32 v50, 192, v44
    v_mfma_f32_16x16x32_bf16 v[196:199], a[36:39], a[72:75], v[196:199]
    ds_read_b64_tr_b16 a[60:61], v51 offset:256
    ds_read_b64_tr_b16 a[62:63], v51 offset:2304
    v_mfma_f32_16x16x32_bf16 v[204:207], a[36:39], a[76:79], v[204:207]
    s_waitcnt lgkmcnt(8)
    v_xor_b32 v51, 224, v44
    v_mfma_f32_16x16x32_bf16 v[208:211], a[40:43], a[72:75], v[208:211]
    s_barrier
    ds_read_b64_tr_b16 a[0:1], v44 offset:0
    ds_read_b64_tr_b16 a[2:3], v44 offset:2048
    v_mfma_f32_16x16x32_bf16 v[216:219], a[40:43], a[76:79], v[216:219]
    ds_read_b128 a[64:67], v40 offset:0
    v_mfma_f32_16x16x32_bf16 v[212:215], a[44:47], a[72:75], v[212:215]
    ds_read_b64_tr_b16 a[4:5], v45 offset:0
    ds_read_b64_tr_b16 a[6:7], v45 offset:2048
    v_mfma_f32_16x16x32_bf16 v[220:223], a[44:47], a[76:79], v[220:223]
    s_waitcnt lgkmcnt(9)
    ds_read_b128 a[68:71], v40 offset:2048
    v_mfma_f32_16x16x32_bf16 v[224:227], a[48:51], a[72:75], v[224:227]
    ds_read_b64_tr_b16 a[8:9], v46 offset:0
    ds_read_b64_tr_b16 a[10:11], v46 offset:2048
    v_mfma_f32_16x16x32_bf16 v[232:235], a[48:51], a[76:79], v[232:235]
    v_mfma_f32_16x16x32_bf16 v[228:231], a[52:55], a[72:75], v[228:231]
    ds_read_b64_tr_b16 a[12:13], v47 offset:0
    ds_read_b64_tr_b16 a[14:15], v47 offset:2048
    v_mfma_f32_16x16x32_bf16 v[236:239], a[52:55], a[76:79], v[236:239]
    s_waitcnt lgkmcnt(10)
    v_mfma_f32_16x16x32_bf16 v[240:243], a[56:59], a[72:75], v[240:243]
    ds_read_b64_tr_b16 a[16:17], v48 offset:0
    ds_read_b64_tr_b16 a[18:19], v48 offset:2048
    v_mfma_f32_16x16x32_bf16 v[248:251], a[56:59], a[76:79], v[248:251]
    v_mfma_f32_16x16x32_bf16 v[244:247], a[60:63], a[72:75], v[244:247]
    ds_read_b64_tr_b16 a[20:21], v49 offset:0
    ds_read_b64_tr_b16 a[22:23], v49 offset:2048
    v_mfma_f32_16x16x32_bf16 v[252:255], a[60:63], a[76:79], v[252:255]
    s_waitcnt lgkmcnt(8)
    v_mfma_f32_16x16x32_bf16 v[128:131], a[0:3], a[64:67], v[128:131]
    ds_read_b64_tr_b16 a[24:25], v50 offset:0
    ds_read_b64_tr_b16 a[26:27], v50 offset:2048
    v_mfma_f32_16x16x32_bf16 v[136:139], a[0:3], a[68:71], v[136:139]
    ds_read_b128 a[72:75], v41 offset:0
    v_mfma_f32_16x16x32_bf16 v[132:135], a[4:7], a[64:67], v[132:135]
    ds_read_b64_tr_b16 a[28:29], v51 offset:0
    ds_read_b64_tr_b16 a[30:31], v51 offset:2048
    v_mfma_f32_16x16x32_bf16 v[140:143], a[4:7], a[68:71], v[140:143]
    s_waitcnt lgkmcnt(9)
    v_mfma_f32_16x16x32_bf16 v[144:147], a[8:11], a[64:67], v[144:147]
    ds_read_b64_tr_b16 a[32:33], v44 offset:256
    ds_read_b64_tr_b16 a[34:35], v44 offset:2304
    v_mfma_f32_16x16x32_bf16 v[152:155], a[8:11], a[68:71], v[152:155]
    ds_read_b128 a[76:79], v41 offset:2048
    v_add_u32 v44, 114688, v16
    v_mfma_f32_16x16x32_bf16 v[148:151], a[12:15], a[64:67], v[148:151]
    ds_read_b64_tr_b16 a[36:37], v45 offset:256
    ds_read_b64_tr_b16 a[38:39], v45 offset:2304
    v_mfma_f32_16x16x32_bf16 v[156:159], a[12:15], a[68:71], v[156:159]
    s_waitcnt lgkmcnt(10)
    v_xor_b32 v45, 32, v44
    v_mfma_f32_16x16x32_bf16 v[160:163], a[16:19], a[64:67], v[160:163]
    ds_read_b64_tr_b16 a[40:41], v46 offset:256
    ds_read_b64_tr_b16 a[42:43], v46 offset:2304
    v_mfma_f32_16x16x32_bf16 v[168:171], a[16:19], a[68:71], v[168:171]
    v_xor_b32 v46, 64, v44
    v_mfma_f32_16x16x32_bf16 v[164:167], a[20:23], a[64:67], v[164:167]
    ds_read_b64_tr_b16 a[44:45], v47 offset:256
    ds_read_b64_tr_b16 a[46:47], v47 offset:2304
    v_mfma_f32_16x16x32_bf16 v[172:175], a[20:23], a[68:71], v[172:175]
    s_waitcnt lgkmcnt(9)
    v_xor_b32 v47, 96, v44
    v_mfma_f32_16x16x32_bf16 v[176:179], a[24:27], a[64:67], v[176:179]
    ds_read_b64_tr_b16 a[48:49], v48 offset:256
    ds_read_b64_tr_b16 a[50:51], v48 offset:2304
    v_mfma_f32_16x16x32_bf16 v[184:187], a[24:27], a[68:71], v[184:187]
    v_xor_b32 v48, 128, v44
    v_mfma_f32_16x16x32_bf16 v[180:183], a[28:31], a[64:67], v[180:183]
    ds_read_b64_tr_b16 a[52:53], v49 offset:256
    ds_read_b64_tr_b16 a[54:55], v49 offset:2304
    v_mfma_f32_16x16x32_bf16 v[188:191], a[28:31], a[68:71], v[188:191]
    s_waitcnt lgkmcnt(8)
    v_xor_b32 v49, 160, v44
    v_mfma_f32_16x16x32_bf16 v[192:195], a[32:35], a[64:67], v[192:195]
    ds_read_b64_tr_b16 a[56:57], v50 offset:256
    ds_read_b64_tr_b16 a[58:59], v50 offset:2304
    v_mfma_f32_16x16x32_bf16 v[200:203], a[32:35], a[68:71], v[200:203]
    v_xor_b32 v50, 192, v44
    v_mfma_f32_16x16x32_bf16 v[196:199], a[36:39], a[64:67], v[196:199]
    ds_read_b64_tr_b16 a[60:61], v51 offset:256
    ds_read_b64_tr_b16 a[62:63], v51 offset:2304
    v_mfma_f32_16x16x32_bf16 v[204:207], a[36:39], a[68:71], v[204:207]
    s_waitcnt lgkmcnt(8)
    v_xor_b32 v51, 224, v44
    v_mfma_f32_16x16x32_bf16 v[208:211], a[40:43], a[64:67], v[208:211]
    s_barrier
    ds_read_b64_tr_b16 a[0:1], v44 offset:0
    ds_read_b64_tr_b16 a[2:3], v44 offset:2048
    v_mfma_f32_16x16x32_bf16 v[216:219], a[40:43], a[68:71], v[216:219]
    v_mfma_f32_16x16x32_bf16 v[212:215], a[44:47], a[64:67], v[212:215]
    ds_read_b64_tr_b16 a[4:5], v45 offset:0
    ds_read_b64_tr_b16 a[6:7], v45 offset:2048
    v_mfma_f32_16x16x32_bf16 v[220:223], a[44:47], a[68:71], v[220:223]
    s_waitcnt lgkmcnt(8)
    v_mfma_f32_16x16x32_bf16 v[224:227], a[48:51], a[64:67], v[224:227]
    ds_read_b64_tr_b16 a[8:9], v46 offset:0
    ds_read_b64_tr_b16 a[10:11], v46 offset:2048
    v_mfma_f32_16x16x32_bf16 v[232:235], a[48:51], a[68:71], v[232:235]
    v_mfma_f32_16x16x32_bf16 v[228:231], a[52:55], a[64:67], v[228:231]
    ds_read_b64_tr_b16 a[12:13], v47 offset:0
    ds_read_b64_tr_b16 a[14:15], v47 offset:2048
    v_mfma_f32_16x16x32_bf16 v[236:239], a[52:55], a[68:71], v[236:239]
    s_waitcnt lgkmcnt(8)
    v_mfma_f32_16x16x32_bf16 v[240:243], a[56:59], a[64:67], v[240:243]
    ds_read_b64_tr_b16 a[16:17], v48 offset:0
    ds_read_b64_tr_b16 a[18:19], v48 offset:2048
    v_mfma_f32_16x16x32_bf16 v[248:251], a[56:59], a[68:71], v[248:251]
    v_mfma_f32_16x16x32_bf16 v[244:247], a[60:63], a[64:67], v[244:247]
    ds_read_b64_tr_b16 a[20:21], v49 offset:0
    ds_read_b64_tr_b16 a[22:23], v49 offset:2048
    v_mfma_f32_16x16x32_bf16 v[252:255], a[60:63], a[68:71], v[252:255]
    s_waitcnt lgkmcnt(8)
    v_mfma_f32_16x16x32_bf16 v[128:131], a[0:3], a[72:75], v[128:131]
    ds_read_b64_tr_b16 a[24:25], v50 offset:0
    ds_read_b64_tr_b16 a[26:27], v50 offset:2048
    v_mfma_f32_16x16x32_bf16 v[136:139], a[0:3], a[76:79], v[136:139]
    v_add_u32 v40, 131072, v17
    v_xor_b32 v41, 64, v40
    v_mfma_f32_16x16x32_bf16 v[132:135], a[4:7], a[72:75], v[132:135]
    ds_read_b64_tr_b16 a[28:29], v51 offset:0
    ds_read_b64_tr_b16 a[30:31], v51 offset:2048
    v_mfma_f32_16x16x32_bf16 v[140:143], a[4:7], a[76:79], v[140:143]
    s_waitcnt lgkmcnt(8)
    v_mfma_f32_16x16x32_bf16 v[144:147], a[8:11], a[72:75], v[144:147]
    ds_read_b64_tr_b16 a[32:33], v44 offset:256
    ds_read_b64_tr_b16 a[34:35], v44 offset:2304
    v_mfma_f32_16x16x32_bf16 v[152:155], a[8:11], a[76:79], v[152:155]
    v_add_u32 v44, 147456, v16
    v_mfma_f32_16x16x32_bf16 v[148:151], a[12:15], a[72:75], v[148:151]
    ds_read_b64_tr_b16 a[36:37], v45 offset:256
    ds_read_b64_tr_b16 a[38:39], v45 offset:2304
    v_mfma_f32_16x16x32_bf16 v[156:159], a[12:15], a[76:79], v[156:159]
    s_waitcnt lgkmcnt(8)
    v_xor_b32 v45, 32, v44
    v_mfma_f32_16x16x32_bf16 v[160:163], a[16:19], a[72:75], v[160:163]
    ds_read_b64_tr_b16 a[40:41], v46 offset:256
    ds_read_b64_tr_b16 a[42:43], v46 offset:2304
    v_mfma_f32_16x16x32_bf16 v[168:171], a[16:19], a[76:79], v[168:171]
    v_xor_b32 v46, 64, v44
    v_mfma_f32_16x16x32_bf16 v[164:167], a[20:23], a[72:75], v[164:167]
    ds_read_b64_tr_b16 a[44:45], v47 offset:256
    ds_read_b64_tr_b16 a[46:47], v47 offset:2304
    v_mfma_f32_16x16x32_bf16 v[172:175], a[20:23], a[76:79], v[172:175]
    s_waitcnt lgkmcnt(8)
    v_xor_b32 v47, 96, v44
    v_mfma_f32_16x16x32_bf16 v[176:179], a[24:27], a[72:75], v[176:179]
    ds_read_b64_tr_b16 a[48:49], v48 offset:256
    ds_read_b64_tr_b16 a[50:51], v48 offset:2304
    v_mfma_f32_16x16x32_bf16 v[184:187], a[24:27], a[76:79], v[184:187]
    v_xor_b32 v48, 128, v44
    v_mfma_f32_16x16x32_bf16 v[180:183], a[28:31], a[72:75], v[180:183]
    ds_read_b64_tr_b16 a[52:53], v49 offset:256
    ds_read_b64_tr_b16 a[54:55], v49 offset:2304
    v_mfma_f32_16x16x32_bf16 v[188:191], a[28:31], a[76:79], v[188:191]
    s_waitcnt lgkmcnt(8)
    v_xor_b32 v49, 160, v44
    v_mfma_f32_16x16x32_bf16 v[192:195], a[32:35], a[72:75], v[192:195]
    ds_read_b64_tr_b16 a[56:57], v50 offset:256
    ds_read_b64_tr_b16 a[58:59], v50 offset:2304
    v_mfma_f32_16x16x32_bf16 v[200:203], a[32:35], a[76:79], v[200:203]
    v_xor_b32 v50, 192, v44
    v_mfma_f32_16x16x32_bf16 v[196:199], a[36:39], a[72:75], v[196:199]
    ds_read_b64_tr_b16 a[60:61], v51 offset:256
    ds_read_b64_tr_b16 a[62:63], v51 offset:2304
    v_mfma_f32_16x16x32_bf16 v[204:207], a[36:39], a[76:79], v[204:207]
    s_waitcnt lgkmcnt(8)
    v_xor_b32 v51, 224, v44
    v_mfma_f32_16x16x32_bf16 v[208:211], a[40:43], a[72:75], v[208:211]
    s_barrier
    ds_read_b64_tr_b16 a[0:1], v44 offset:0
    ds_read_b64_tr_b16 a[2:3], v44 offset:2048
    v_mfma_f32_16x16x32_bf16 v[216:219], a[40:43], a[76:79], v[216:219]
    ds_read_b128 a[64:67], v40 offset:0
    v_mfma_f32_16x16x32_bf16 v[212:215], a[44:47], a[72:75], v[212:215]
    ds_read_b64_tr_b16 a[4:5], v45 offset:0
    ds_read_b64_tr_b16 a[6:7], v45 offset:2048
    v_mfma_f32_16x16x32_bf16 v[220:223], a[44:47], a[76:79], v[220:223]
    s_waitcnt lgkmcnt(9)
    ds_read_b128 a[68:71], v40 offset:2048
    v_mfma_f32_16x16x32_bf16 v[224:227], a[48:51], a[72:75], v[224:227]
    ds_read_b64_tr_b16 a[8:9], v46 offset:0
    ds_read_b64_tr_b16 a[10:11], v46 offset:2048
    v_mfma_f32_16x16x32_bf16 v[232:235], a[48:51], a[76:79], v[232:235]
    v_mfma_f32_16x16x32_bf16 v[228:231], a[52:55], a[72:75], v[228:231]
    ds_read_b64_tr_b16 a[12:13], v47 offset:0
    ds_read_b64_tr_b16 a[14:15], v47 offset:2048
    v_mfma_f32_16x16x32_bf16 v[236:239], a[52:55], a[76:79], v[236:239]
    s_waitcnt lgkmcnt(10)
    v_mfma_f32_16x16x32_bf16 v[240:243], a[56:59], a[72:75], v[240:243]
    ds_read_b64_tr_b16 a[16:17], v48 offset:0
    ds_read_b64_tr_b16 a[18:19], v48 offset:2048
    v_mfma_f32_16x16x32_bf16 v[248:251], a[56:59], a[76:79], v[248:251]
    v_mfma_f32_16x16x32_bf16 v[244:247], a[60:63], a[72:75], v[244:247]
    ds_read_b64_tr_b16 a[20:21], v49 offset:0
    ds_read_b64_tr_b16 a[22:23], v49 offset:2048
    v_mfma_f32_16x16x32_bf16 v[252:255], a[60:63], a[76:79], v[252:255]
    s_waitcnt lgkmcnt(8)
    v_mfma_f32_16x16x32_bf16 v[128:131], a[0:3], a[64:67], v[128:131]
    ds_read_b64_tr_b16 a[24:25], v50 offset:0
    ds_read_b64_tr_b16 a[26:27], v50 offset:2048
    v_mfma_f32_16x16x32_bf16 v[136:139], a[0:3], a[68:71], v[136:139]
    ds_read_b128 a[72:75], v41 offset:0
    v_mfma_f32_16x16x32_bf16 v[132:135], a[4:7], a[64:67], v[132:135]
    ds_read_b64_tr_b16 a[28:29], v51 offset:0
    ds_read_b64_tr_b16 a[30:31], v51 offset:2048
    v_mfma_f32_16x16x32_bf16 v[140:143], a[4:7], a[68:71], v[140:143]
    s_waitcnt lgkmcnt(9)
    v_mfma_f32_16x16x32_bf16 v[144:147], a[8:11], a[64:67], v[144:147]
    ds_read_b64_tr_b16 a[32:33], v44 offset:256
    ds_read_b64_tr_b16 a[34:35], v44 offset:2304
    v_mfma_f32_16x16x32_bf16 v[152:155], a[8:11], a[68:71], v[152:155]
    ds_read_b128 a[76:79], v41 offset:2048
    v_add_u32 v44, 49152, v16
    v_mfma_f32_16x16x32_bf16 v[148:151], a[12:15], a[64:67], v[148:151]
    ds_read_b64_tr_b16 a[36:37], v45 offset:256
L_pg2:
    s_cbranch_execz L_warm_done
    ds_read_b64_tr_b16 a[38:39], v45 offset:2304
    v_mfma_f32_16x16x32_bf16 v[156:159], a[12:15], a[68:71], v[156:159]
    s_waitcnt lgkmcnt(10)
    v_xor_b32 v45, 32, v44
    v_mfma_f32_16x16x32_bf16 v[160:163], a[16:19], a[64:67], v[160:163]
    ds_read_b64_tr_b16 a[40:41], v46 offset:256
    ds_read_b64_tr_b16 a[42:43], v46 offset:2304
    v_mfma_f32_16x16x32_bf16 v[168:171], a[16:19], a[68:71], v[168:171]
    v_xor_b32 v46, 64, v44
    v_mfma_f32_16x16x32_bf16 v[164:167], a[20:23], a[64:67], v[164:167]
    ds_read_b64_tr_b16 a[44:45], v47 offset:256
    ds_read_b64_tr_b16 a[46:47], v47 offset:2304
    v_mfma_f32_16x16x32_bf16 v[172:175], a[20:23], a[68:71], v[172:175]
    s_waitcnt lgkmcnt(9)
    v_xor_b32 v47, 96, v44
    v_mfma_f32_16x16x32_bf16 v[176:179], a[24:27], a[64:67], v[176:179]
    ds_read_b64_tr_b16 a[48:49], v48 offset:256
    ds_read_b64_tr_b16 a[50:51], v48 offset:2304
    v_mfma_f32_16x16x32_bf16 v[184:187], a[24:27], a[68:71], v[184:187]
    v_xor_b32 v48, 128, v44
    v_mfma_f32_16x16x32_bf16 v[180:183], a[28:31], a[64:67], v[180:183]
    ds_read_b64_tr_b16 a[52:53], v49 offset:256
    ds_read_b64_tr_b16 a[54:55], v49 offset:2304
    v_mfma_f32_16x16x32_bf16 v[188:191], a[28:31], a[68:71], v[188:191]
    s_waitcnt lgkmcnt(8)
    v_xor_b32 v49, 160, v44
    v_mfma_f32_16x16x32_bf16 v[192:195], a[32:35], a[64:67], v[192:195]
    ds_read_b64_tr_b16 a[56:57], v50 offset:256
    ds_read_b64_tr_b16 a[58:59], v50 offset:2304
    v_mfma_f32_16x16x32_bf16 v[200:203], a[32:35], a[68:71], v[200:203]
    v_xor_b32 v50, 192, v44
    v_mfma_f32_16x16x32_bf16 v[196:199], a[36:39], a[64:67], v[196:199]
    ds_read_b64_tr_b16 a[60:61], v51 offset:256
    ds_read_b64_tr_b16 a[62:63], v51 offset:2304
    v_mfma_f32_16x16x32_bf16 v[204:207], a[36:39], a[68:71], v[204:207]
    s_waitcnt lgkmcnt(8)
    v_xor_b32 v51, 224, v44
    v_mfma_f32_16x16x32_bf16 v[208:211], a[40:43], a[64:67], v[208:211]
    s_barrier
    ds_read_b64_tr_b16 a[0:1], v44 offset:0
    ds_read_b64_tr_b16 a[2:3], v44 offset:2048
    v_mfma_f32_16x16x32_bf16 v[216:219], a[40:43], a[68:71], v[216:219]
    v_mfma_f32_16x16x32_bf16 v[212:215], a[44:47], a[64:67], v[212:215]
    ds_read_b64_tr_b16 a[4:5], v45 offset:0
    ds_read_b64_tr_b16 a[6:7], v45 offset:2048
    v_mfma_f32_16x16x32_bf16 v[220:223], a[44:47], a[68:71], v[220:223]
    s_waitcnt lgkmcnt(8)
    v_mfma_f32_16x16x32_bf16 v[224:227], a[48:51], a[64:67], v[224:227]
    ds_read_b64_tr_b16 a[8:9], v46 offset:0
    ds_read_b64_tr_b16 a[10:11], v46 offset:2048
    v_mfma_f32_16x16x32_bf16 v[232:235], a[48:51], a[68:71], v[232:235]
    v_mfma_f32_16x16x32_bf16 v[228:231], a[52:55], a[64:67], v[228:231]
    ds_read_b64_tr_b16 a[12:13], v47 offset:0
    ds_read_b64_tr_b16 a[14:15], v47 offset:2048
    v_mfma_f32_16x16x32_bf16 v[236:239], a[52:55], a[68:71], v[236:239]
    s_waitcnt lgkmcnt(8)
    v_mfma_f32_16x16x32_bf16 v[240:243], a[56:59], a[64:67], v[240:243]
    ds_read_b64_tr_b16 a[16:17], v48 offset:0
    ds_read_b64_tr_b16 a[18:19], v48 offset:2048
    v_mfma_f32_16x16x32_bf16 v[248:251], a[56:59], a[68:71], v[248:251]
    v_mfma_f32_16x16x32_bf16 v[244:247], a[60:63], a[64:67], v[244:247]
    ds_read_b64_tr_b16 a[20:21], v49 offset:0
    ds_read_b64_tr_b16 a[22:23], v49 offset:2048
    v_mfma_f32_16x16x32_bf16 v[252:255], a[60:63], a[68:71], v[252:255]
    s_waitcnt lgkmcnt(8)
    v_mfma_f32_16x16x32_bf16 v[128:131], a[0:3], a[72:75], v[128:131]
    ds_read_b64_tr_b16 a[24:25], v50 offset:0
    ds_read_b64_tr_b16 a[26:27], v50 offset:2048
    v_mfma_f32_16x16x32_bf16 v[136:139], a[0:3], a[76:79], v[136:139]
    v_add_u32 v40, 65536, v17
    v_xor_b32 v41, 64, v40
    v_mfma_f32_16x16x32_bf16 v[132:135], a[4:7], a[72:75], v[132:135]
    ds_read_b64_tr_b16 a[28:29], v51 offset:0
    ds_read_b64_tr_b16 a[30:31], v51 offset:2048
    v_mfma_f32_16x16x32_bf16 v[140:143], a[4:7], a[76:79], v[140:143]
    s_waitcnt lgkmcnt(8)
    v_mfma_f32_16x16x32_bf16 v[144:147], a[8:11], a[72:75], v[144:147]
    ds_read_b64_tr_b16 a[32:33], v44 offset:256
    ds_read_b64_tr_b16 a[34:35], v44 offset:2304
    v_mfma_f32_16x16x32_bf16 v[152:155], a[8:11], a[76:79], v[152:155]
    v_add_u32 v44, 81920, v16
    v_mfma_f32_16x16x32_bf16 v[148:151], a[12:15], a[72:75], v[148:151]
    ds_read_b64_tr_b16 a[36:37], v45 offset:256
    ds_read_b64_tr_b16 a[38:39], v45 offset:2304
    v_mfma_f32_16x16x32_bf16 v[156:159], a[12:15], a[76:79], v[156:159]
    s_waitcnt lgkmcnt(8)
    v_xor_b32 v45, 32, v44
    v_mfma_f32_16x16x32_bf16 v[160:163], a[16:19], a[72:75], v[160:163]
    ds_read_b64_tr_b16 a[40:41], v46 offset:256
    ds_read_b64_tr_b16 a[42:43], v46 offset:2304
    v_mfma_f32_16x16x32_bf16 v[168:171], a[16:19], a[76:79], v[168:171]
    v_xor_b32 v46, 64, v44
    v_mfma_f32_16x16x32_bf16 v[164:167], a[20:23], a[72:75], v[164:167]
    ds_read_b64_tr_b16 a[44:45], v47 offset:256
    ds_read_b64_tr_b16 a[46:47], v47 offset:2304
    v_mfma_f32_16x16x32_bf16 v[172:175], a[20:23], a[76:79], v[172:175]
    s_waitcnt lgkmcnt(8)
    v_xor_b32 v47, 96, v44
    v_mfma_f32_16x16x32_bf16 v[176:179], a[24:27], a[72:75], v[176:179]
    ds_read_b64_tr_b16 a[48:49], v48 offset:256
    ds_read_b64_tr_b16 a[50:51], v48 offset:2304
    v_mfma_f32_16x16x32_bf16 v[184:187], a[24:27], a[76:79], v[184:187]
    v_xor_b32 v48, 128, v44
    v_mfma_f32_16x16x32_bf16 v[180:183], a[28:31], a[72:75], v[180:183]
    ds_read_b64_tr_b16 a[52:53], v49 offset:256
    ds_read_b64_tr_b16 a[54:55], v49 offset:2304
    v_mfma_f32_16x16x32_bf16 v[188:191], a[28:31], a[76:79], v[188:191]
    s_waitcnt lgkmcnt(8)
    v_xor_b32 v49, 160, v44
    v_mfma_f32_16x16x32_bf16 v[192:195], a[32:35], a[72:75], v[192:195]
    ds_read_b64_tr_b16 a[56:57], v50 offset:256
    ds_read_b64_tr_b16 a[58:59], v50 offset:2304
    v_mfma_f32_16x16x32_bf16 v[200:203], a[32:35], a[76:79], v[200:203]
    v_xor_b32 v50, 192, v44
    v_mfma_f32_16x16x32_bf16 v[196:199], a[36:39], a[72:75], v[196:199]
    ds_read_b64_tr_b16 a[60:61], v51 offset:256
    ds_read_b64_tr_b16 a[62:63], v51 offset:2304
    v_mfma_f32_16x16x32_bf16 v[204:207], a[36:39], a[76:79], v[204:207]
    s_waitcnt lgkmcnt(8)
    v_xor_b32 v51, 224, v44
    v_mfma_f32_16x16x32_bf16 v[208:211], a[40:43], a[72:75], v[208:211]
    s_barrier
    ds_read_b64_tr_b16 a[0:1], v44 offset:0
    ds_read_b64_tr_b16 a[2:3], v44 offset:2048
    v_mfma_f32_16x16x32_bf16 v[216:219], a[40:43], a[76:79], v[216:219]
    ds_read_b128 a[64:67], v40 offset:0
    v_mfma_f32_16x16x32_bf16 v[212:215], a[44:47], a[72:75], v[212:215]
    ds_read_b64_tr_b16 a[4:5], v45 offset:0
    ds_read_b64_tr_b16 a[6:7], v45 offset:2048
    v_mfma_f32_16x16x32_bf16 v[220:223], a[44:47], a[76:79], v[220:223]
    s_waitcnt lgkmcnt(9)
    ds_read_b128 a[68:71], v40 offset:2048
    v_mfma_f32_16x16x32_bf16 v[224:227], a[48:51], a[72:75], v[224:227]
    ds_read_b64_tr_b16 a[8:9], v46 offset:0
    ds_read_b64_tr_b16 a[10:11], v46 offset:2048
    v_mfma_f32_16x16x32_bf16 v[232:235], a[48:51], a[76:79], v[232:235]
    v_mfma_f32_16x16x32_bf16 v[228:231], a[52:55], a[72:75], v[228:231]
    ds_read_b64_tr_b16 a[12:13], v47 offset:0
    ds_read_b64_tr_b16 a[14:15], v47 offset:2048
    v_mfma_f32_16x16x32_bf16 v[236:239], a[52:55], a[76:79], v[236:239]
    s_waitcnt lgkmcnt(10)
    v_mfma_f32_16x16x32_bf16 v[240:243], a[56:59], a[72:75], v[240:243]
    ds_read_b64_tr_b16 a[16:17], v48 offset:0
    ds_read_b64_tr_b16 a[18:19], v48 offset:2048
    v_mfma_f32_16x16x32_bf16 v[248:251], a[56:59], a[76:79], v[248:251]
    v_mfma_f32_16x16x32_bf16 v[244:247], a[60:63], a[72:75], v[244:247]
    ds_read_b64_tr_b16 a[20:21], v49 offset:0
    ds_read_b64_tr_b16 a[22:23], v49 offset:2048
    v_mfma_f32_16x16x32_bf16 v[252:255], a[60:63], a[76:79], v[252:255]
    s_waitcnt lgkmcnt(8)
    v_mfma_f32_16x16x32_bf16 v[128:131], a[0:3], a[64:67], v[128:131]
    ds_read_b64_tr_b16 a[24:25], v50 offset:0
    ds_read_b64_tr_b16 a[26:27], v50 offset:2048
    v_mfma_f32_16x16x32_bf16 v[136:139], a[0:3], a[68:71], v[136:139]
    ds_read_b128 a[72:75], v41 offset:0
    v_mfma_f32_16x16x32_bf16 v[132:135], a[4:7], a[64:67], v[132:135]
    ds_read_b64_tr_b16 a[28:29], v51 offset:0
    ds_read_b64_tr_b16 a[30:31], v51 offset:2048
    v_mfma_f32_16x16x32_bf16 v[140:143], a[4:7], a[68:71], v[140:143]
    s_waitcnt lgkmcnt(9)
    v_mfma_f32_16x16x32_bf16 v[144:147], a[8:11], a[64:67], v[144:147]
    ds_read_b64_tr_b16 a[32:33], v44 offset:256
    ds_read_b64_tr_b16 a[34:35], v44 offset:2304
    v_mfma_f32_16x16x32_bf16 v[152:155], a[8:11], a[68:71], v[152:155]
    ds_read_b128 a[76:79], v41 offset:2048
    v_add_u32 v44, 98304, v16
    v_mfma_f32_16x16x32_bf16 v[148:151], a[12:15], a[64:67], v[148:151]
    ds_read_b64_tr_b16 a[36:37], v45 offset:256
    ds_read_b64_tr_b16 a[38:39], v45 offset:2304
    v_mfma_f32_16x16x32_bf16 v[156:159], a[12:15], a[68:71], v[156:159]
    s_waitcnt lgkmcnt(10)
    v_xor_b32 v45, 32, v44
    v_mfma_f32_16x16x32_bf16 v[160:163], a[16:19], a[64:67], v[160:163]
    ds_read_b64_tr_b16 a[40:41], v46 offset:256
    ds_read_b64_tr_b16 a[42:43], v46 offset:2304
    v_mfma_f32_16x16x32_bf16 v[168:171], a[16:19], a[68:71], v[168:171]
    v_xor_b32 v46, 64, v44
    v_mfma_f32_16x16x32_bf16 v[164:167], a[20:23], a[64:67], v[164:167]
    ds_read_b64_tr_b16 a[44:45], v47 offset:256
    ds_read_b64_tr_b16 a[46:47], v47 offset:2304
    v_mfma_f32_16x16x32_bf16 v[172:175], a[20:23], a[68:71], v[172:175]
    s_waitcnt lgkmcnt(9)
    v_xor_b32 v47, 96, v44
    v_mfma_f32_16x16x32_bf16 v[176:179], a[24:27], a[64:67], v[176:179]
    ds_read_b64_tr_b16 a[48:49], v48 offset:256
    ds_read_b64_tr_b16 a[50:51], v48 offset:2304
    v_mfma_f32_16x16x32_bf16 v[184:187], a[24:27], a[68:71], v[184:187]
    v_xor_b32 v48, 128, v44
    v_mfma_f32_16x16x32_bf16 v[180:183], a[28:31], a[64:67], v[180:183]
    ds_read_b64_tr_b16 a[52:53], v49 offset:256
    ds_read_b64_tr_b16 a[54:55], v49 offset:2304
    v_mfma_f32_16x16x32_bf16 v[188:191], a[28:31], a[68:71], v[188:191]
    s_waitcnt lgkmcnt(8)
    v_xor_b32 v49, 160, v44
    v_mfma_f32_16x16x32_bf16 v[192:195], a[32:35], a[64:67], v[192:195]
    ds_read_b64_tr_b16 a[56:57], v50 offset:256
    ds_read_b64_tr_b16 a[58:59], v50 offset:2304
    v_mfma_f32_16x16x32_bf16 v[200:203], a[32:35], a[68:71], v[200:203]
    v_xor_b32 v50, 192, v44
    v_mfma_f32_16x16x32_bf16 v[196:199], a[36:39], a[64:67], v[196:199]
    ds_read_b64_tr_b16 a[60:61], v51 offset:256
    ds_read_b64_tr_b16 a[62:63], v51 offset:2304
    v_mfma_f32_16x16x32_bf16 v[204:207], a[36:39], a[68:71], v[204:207]
    s_waitcnt lgkmcnt(8)
    v_xor_b32 v51, 224, v44
    v_mfma_f32_16x16x32_bf16 v[208:211], a[40:43], a[64:67], v[208:211]
    s_barrier
    ds_read_b64_tr_b16 a[0:1], v44 offset:0
    ds_read_b64_tr_b16 a[2:3], v44 offset:2048
    v_mfma_f32_16x16x32_bf16 v[216:219], a[40:43], a[68:71], v[216:219]
    v_mfma_f32_16x16x32_bf16 v[212:215], a[44:47], a[64:67], v[212:215]
    ds_read_b64_tr_b16 a[4:5], v45 offset:0
    ds_read_b64_tr_b16 a[6:7], v45 offset:2048
    v_mfma_f32_16x16x32_bf16 v[220:223], a[44:47], a[68:71], v[220:223]
    s_waitcnt lgkmcnt(8)
    v_mfma_f32_16x16x32_bf16 v[224:227], a[48:51], a[64:67], v[224:227]
    ds_read_b64_tr_b16 a[8:9], v46 offset:0
    ds_read_b64_tr_b16 a[10:11], v46 offset:2048
    v_mfma_f32_16x16x32_bf16 v[232:235], a[48:51], a[68:71], v[232:235]
    v_mfma_f32_16x16x32_bf16 v[228:231], a[52:55], a[64:67], v[228:231]
    ds_read_b64_tr_b16 a[12:13], v47 offset:0
    ds_read_b64_tr_b16 a[14:15], v47 offset:2048
    v_mfma_f32_16x16x32_bf16 v[236:239], a[52:55], a[68:71], v[236:239]
    s_waitcnt lgkmcnt(8)
    v_mfma_f32_16x16x32_bf16 v[240:243], a[56:59], a[64:67], v[240:243]
    ds_read_b64_tr_b16 a[16:17], v48 offset:0
    ds_read_b64_tr_b16 a[18:19], v48 offset:2048
    v_mfma_f32_16x16x32_bf16 v[248:251], a[56:59], a[68:71], v[248:251]
    v_mfma_f32_16x16x32_bf16 v[244:247], a[60:63], a[64:67], v[244:247]
    ds_read_b64_tr_b16 a[20:21], v49 offset:0
    ds_read_b64_tr_b16 a[22:23], v49 offset:2048
    v_mfma_f32_16x16x32_bf16 v[252:255], a[60:63], a[68:71], v[252:255]
    s_waitcnt lgkmcnt(8)
    v_mfma_f32_16x16x32_bf16 v[128:131], a[0:3], a[72:75], v[128:131]
    ds_read_b64_tr_b16 a[24:25], v50 offset:0
    ds_read_b64_tr_b16 a[26:27], v50 offset:2048
    v_mfma_f32_16x16x32_bf16 v[136:139], a[0:3], a[76:79], v[136:139]
    v_add_u32 v40, 114688, v17
    v_xor_b32 v41, 64, v40
    v_mfma_f32_16x16x32_bf16 v[132:135], a[4:7], a[72:75], v[132:135]
    ds_read_b64_tr_b16 a[28:29], v51 offset:0
    ds_read_b64_tr_b16 a[30:31], v51 offset:2048
    v_mfma_f32_16x16x32_bf16 v[140:143], a[4:7], a[76:79], v[140:143]
    s_waitcnt lgkmcnt(8)
    v_mfma_f32_16x16x32_bf16 v[144:147], a[8:11], a[72:75], v[144:147]
    ds_read_b64_tr_b16 a[32:33], v44 offset:256
    ds_read_b64_tr_b16 a[34:35], v44 offset:2304
    v_mfma_f32_16x16x32_bf16 v[152:155], a[8:11], a[76:79], v[152:155]
    v_add_u32 v44, 131072, v16
    v_mfma_f32_16x16x32_bf16 v[148:151], a[12:15], a[72:75], v[148:151]
    ds_read_b64_tr_b16 a[36:37], v45 offset:256
    ds_read_b64_tr_b16 a[38:39], v45 offset:2304
    v_mfma_f32_16x16x32_bf16 v[156:159], a[12:15], a[76:79], v[156:159]
    s_waitcnt lgkmcnt(8)
    v_xor_b32 v45, 32, v44
    v_mfma_f32_16x16x32_bf16 v[160:163], a[16:19], a[72:75], v[160:163]
    ds_read_b64_tr_b16 a[40:41], v46 offset:256
    ds_read_b64_tr_b16 a[42:43], v46 offset:2304
    v_mfma_f32_16x16x32_bf16 v[168:171], a[16:19], a[76:79], v[168:171]
    v_xor_b32 v46, 64, v44
    v_mfma_f32_16x16x32_bf16 v[164:167], a[20:23], a[72:75], v[164:167]
    ds_read_b64_tr_b16 a[44:45], v47 offset:256
    ds_read_b64_tr_b16 a[46:47], v47 offset:2304
    v_mfma_f32_16x16x32_bf16 v[172:175], a[20:23], a[76:79], v[172:175]
    s_waitcnt lgkmcnt(8)
    v_xor_b32 v47, 96, v44
    v_mfma_f32_16x16x32_bf16 v[176:179], a[24:27], a[72:75], v[176:179]
    ds_read_b64_tr_b16 a[48:49], v48 offset:256
    ds_read_b64_tr_b16 a[50:51], v48 offset:2304
    v_mfma_f32_16x16x32_bf16 v[184:187], a[24:27], a[76:79], v[184:187]
    v_xor_b32 v48, 128, v44
    v_mfma_f32_16x16x32_bf16 v[180:183], a[28:31], a[72:75], v[180:183]
    ds_read_b64_tr_b16 a[52:53], v49 offset:256
    ds_read_b64_tr_b16 a[54:55], v49 offset:2304
    v_mfma_f32_16x16x32_bf16 v[188:191], a[28:31], a[76:79], v[188:191]
    s_waitcnt lgkmcnt(8)
    v_xor_b32 v49, 160, v44
    v_mfma_f32_16x16x32_bf16 v[192:195], a[32:35], a[72:75], v[192:195]
    ds_read_b64_tr_b16 a[56:57], v50 offset:256
    ds_read_b64_tr_b16 a[58:59], v50 offset:2304
    v_mfma_f32_16x16x32_bf16 v[200:203], a[32:35], a[76:79], v[200:203]
    v_xor_b32 v50, 192, v44
    v_mfma_f32_16x16x32_bf16 v[196:199], a[36:39], a[72:75], v[196:199]
    ds_read_b64_tr_b16 a[60:61], v51 offset:256
    ds_read_b64_tr_b16 a[62:63], v51 offset:2304
    v_mfma_f32_16x16x32_bf16 v[204:207], a[36:39], a[76:79], v[204:207]
    s_waitcnt lgkmcnt(8)
    v_xor_b32 v51, 224, v44
    v_mfma_f32_16x16x32_bf16 v[208:211], a[40:43], a[72:75], v[208:211]
    s_barrier
    ds_read_b64_tr_b16 a[0:1], v44 offset:0
    ds_read_b64_tr_b16 a[2:3], v44 offset:2048
    v_mfma_f32_16x16x32_bf16 v[216:219], a[40:43], a[76:79], v[216:219]
    ds_read_b128 a[64:67], v40 offset:0
    v_mfma_f32_16x16x32_bf16 v[212:215], a[44:47], a[72:75], v[212:215]
    ds_read_b64_tr_b16 a[4:5], v45 offset:0
    ds_read_b64_tr_b16 a[6:7], v45 offset:2048
    v_mfma_f32_16x16x32_bf16 v[220:223], a[44:47], a[76:79], v[220:223]
    s_waitcnt lgkmcnt(9)
    ds_read_b128 a[68:71], v40 offset:2048
    v_mfma_f32_16x16x32_bf16 v[224:227], a[48:51], a[72:75], v[224:227]
    ds_read_b64_tr_b16 a[8:9], v46 offset:0
    ds_read_b64_tr_b16 a[10:11], v46 offset:2048
    v_mfma_f32_16x16x32_bf16 v[232:235], a[48:51], a[76:79], v[232:235]
    v_mfma_f32_16x16x32_bf16 v[228:231], a[52:55], a[72:75], v[228:231]
    ds_read_b64_tr_b16 a[12:13], v47 offset:0
    ds_read_b64_tr_b16 a[14:15], v47 offset:2048
    v_mfma_f32_16x16x32_bf16 v[236:239], a[52:55], a[76:79], v[236:239]
    s_waitcnt lgkmcnt(10)
    v_mfma_f32_16x16x32_bf16 v[240:243], a[56:59], a[72:75], v[240:243]
    ds_read_b64_tr_b16 a[16:17], v48 offset:0
    ds_read_b64_tr_b16 a[18:19], v48 offset:2048
    v_mfma_f32_16x16x32_bf16 v[248:251], a[56:59], a[76:79], v[248:251]
    v_mfma_f32_16x16x32_bf16 v[244:247], a[60:63], a[72:75], v[244:247]
    ds_read_b64_tr_b16 a[20:21], v49 offset:0
    ds_read_b64_tr_b16 a[22:23], v49 offset:2048
    v_mfma_f32_16x16x32_bf16 v[252:255], a[60:63], a[76:79], v[252:255]
    s_waitcnt lgkmcnt(8)
    v_mfma_f32_16x16x32_bf16 v[128:131], a[0:3], a[64:67], v[128:131]
    ds_read_b64_tr_b16 a[24:25], v50 offset:0
    ds_read_b64_tr_b16 a[26:27], v50 offset:2048
    v_mfma_f32_16x16x32_bf16 v[136:139], a[0:3], a[68:71], v[136:139]
    ds_read_b128 a[72:75], v41 offset:0
    v_mfma_f32_16x16x32_bf16 v[132:135], a[4:7], a[64:67], v[132:135]
    ds_read_b64_tr_b16 a[28:29], v51 offset:0
    ds_read_b64_tr_b16 a[30:31], v51 offset:2048
    v_mfma_f32_16x16x32_bf16 v[140:143], a[4:7], a[68:71], v[140:143]
    s_waitcnt lgkmcnt(9)
    v_mfma_f32_16x16x32_bf16 v[144:147], a[8:11], a[64:67], v[144:147]
    ds_read_b64_tr_b16 a[32:33], v44 offset:256
    ds_read_b64_tr_b16 a[34:35], v44 offset:2304
    v_mfma_f32_16x16x32_bf16 v[152:155], a[8:11], a[68:71], v[152:155]
    ds_read_b128 a[76:79], v41 offset:2048
    v_add_u32 v44, 147456, v16
    v_mfma_f32_16x16x32_bf16 v[148:151], a[12:15], a[64:67], v[148:151]
    ds_read_b64_tr_b16 a[36:37], v45 offset:256
    ds_read_b64_tr_b16 a[38:39], v45 offset:2304
    v_mfma_f32_16x16x32_bf16 v[156:159], a[12:15], a[68:71], v[156:159]
    s_waitcnt lgkmcnt(10)
    v_xor_b32 v45, 32, v44
    v_mfma_f32_16x16x32_bf16 v[160:163], a[16:19], a[64:67], v[160:163]
    ds_read_b64_tr_b16 a[40:41], v46 offset:256
    ds_read_b64_tr_b16 a[42:43], v46 offset:2304
    v_mfma_f32_16x16x32_bf16 v[168:171], a[16:19], a[68:71], v[168:171]
    v_xor_b32 v46, 64, v44
    v_mfma_f32_16x16x32_bf16 v[164:167], a[20:23], a[64:67], v[164:167]
    ds_read_b64_tr_b16 a[44:45], v47 offset:256
    ds_read_b64_tr_b16 a[46:47], v47 offset:2304
    v_mfma_f32_16x16x32_bf16 v[172:175], a[20:23], a[68:71], v[172:175]
    s_waitcnt lgkmcnt(9)
    v_xor_b32 v47, 96, v44
    v_mfma_f32_16x16x32_bf16 v[176:179], a[24:27], a[64:67], v[176:179]
    ds_read_b64_tr_b16 a[48:49], v48 offset:256
    ds_read_b64_tr_b16 a[50:51], v48 offset:2304
    v_mfma_f32_16x16x32_bf16 v[184:187], a[24:27], a[68:71], v[184:187]
    v_xor_b32 v48, 128, v44
    v_mfma_f32_16x16x32_bf16 v[180:183], a[28:31], a[64:67], v[180:183]
    ds_read_b64_tr_b16 a[52:53], v49 offset:256
    ds_read_b64_tr_b16 a[54:55], v49 offset:2304
    v_mfma_f32_16x16x32_bf16 v[188:191], a[28:31], a[68:71], v[188:191]
    s_waitcnt lgkmcnt(8)
    v_xor_b32 v49, 160, v44
    v_mfma_f32_16x16x32_bf16 v[192:195], a[32:35], a[64:67], v[192:195]
    ds_read_b64_tr_b16 a[56:57], v50 offset:256
    ds_read_b64_tr_b16 a[58:59], v50 offset:2304
    v_mfma_f32_16x16x32_bf16 v[200:203], a[32:35], a[68:71], v[200:203]
    v_xor_b32 v50, 192, v44
    v_mfma_f32_16x16x32_bf16 v[196:199], a[36:39], a[64:67], v[196:199]
    ds_read_b64_tr_b16 a[60:61], v51 offset:256
    ds_read_b64_tr_b16 a[62:63], v51 offset:2304
    v_mfma_f32_16x16x32_bf16 v[204:207], a[36:39], a[68:71], v[204:207]
    s_waitcnt lgkmcnt(8)
    v_xor_b32 v51, 224, v44
    v_mfma_f32_16x16x32_bf16 v[208:211], a[40:43], a[64:67], v[208:211]
    s_barrier
    ds_read_b64_tr_b16 a[0:1], v44 offset:0
    ds_read_b64_tr_b16 a[2:3], v44 offset:2048
    v_mfma_f32_16x16x32_bf16 v[216:219], a[40:43], a[68:71], v[216:219]
    v_mfma_f32_16x16x32_bf16 v[212:215], a[44:47], a[64:67], v[212:215]
    ds_read_b64_tr_b16 a[4:5], v45 offset:0
    ds_read_b64_tr_b16 a[6:7], v45 offset:2048
    v_mfma_f32_16x16x32_bf16 v[220:223], a[44:47], a[68:71], v[220:223]
    s_waitcnt lgkmcnt(8)
    v_mfma_f32_16x16x32_bf16 v[224:227], a[48:51], a[64:67], v[224:227]
    ds_read_b64_tr_b16 a[8:9], v46 offset:0
    ds_read_b64_tr_b16 a[10:11], v46 offset:2048
    v_mfma_f32_16x16x32_bf16 v[232:235], a[48:51], a[68:71], v[232:235]
    v_mfma_f32_16x16x32_bf16 v[228:231], a[52:55], a[64:67], v[228:231]
    ds_read_b64_tr_b16 a[12:13], v47 offset:0
    ds_read_b64_tr_b16 a[14:15], v47 offset:2048
    v_mfma_f32_16x16x32_bf16 v[236:239], a[52:55], a[68:71], v[236:239]
    s_waitcnt lgkmcnt(8)
    v_mfma_f32_16x16x32_bf16 v[240:243], a[56:59], a[64:67], v[240:243]
    ds_read_b64_tr_b16 a[16:17], v48 offset:0
    ds_read_b64_tr_b16 a[18:19], v48 offset:2048
    v_mfma_f32_16x16x32_bf16 v[248:251], a[56:59], a[68:71], v[248:251]
    v_mfma_f32_16x16x32_bf16 v[244:247], a[60:63], a[64:67], v[244:247]
    ds_read_b64_tr_b16 a[20:21], v49 offset:0
    ds_read_b64_tr_b16 a[22:23], v49 offset:2048
    v_mfma_f32_16x16x32_bf16 v[252:255], a[60:63], a[68:71], v[252:255]
    s_waitcnt lgkmcnt(8)
    v_mfma_f32_16x16x32_bf16 v[128:131], a[0:3], a[72:75], v[128:131]
    ds_read_b64_tr_b16 a[24:25], v50 offset:0
    ds_read_b64_tr_b16 a[26:27], v50 offset:2048
    v_mfma_f32_16x16x32_bf16 v[136:139], a[0:3], a[76:79], v[136:139]
    v_accvgpr_read_b32 v40, a80
    v_add_u32 v40, 0, v40
    v_mfma_f32_16x16x32_bf16 v[132:135], a[4:7], a[72:75], v[132:135]
    ds_read_b64_tr_b16 a[28:29], v51 offset:0
    ds_read_b64_tr_b16 a[30:31], v51 offset:2048
    v_mfma_f32_16x16x32_bf16 v[140:143], a[4:7], a[76:79], v[140:143]
    s_waitcnt lgkmcnt(8)
    v_xor_b32 v41, 64, v40
    v_xor_b32 v42, 128, v40
    v_mfma_f32_16x16x32_bf16 v[144:147], a[8:11], a[72:75], v[144:147]
    ds_read_b64_tr_b16 a[32:33], v44 offset:256
    ds_read_b64_tr_b16 a[34:35], v44 offset:2304
    v_mfma_f32_16x16x32_bf16 v[152:155], a[8:11], a[76:79], v[152:155]
    v_xor_b32 v43, 192, v40
    v_mfma_f32_16x16x32_bf16 v[148:151], a[12:15], a[72:75], v[148:151]
    ds_read_b64_tr_b16 a[36:37], v45 offset:256
    ds_read_b64_tr_b16 a[38:39], v45 offset:2304
    v_mfma_f32_16x16x32_bf16 v[156:159], a[12:15], a[76:79], v[156:159]
    s_waitcnt lgkmcnt(8)
    v_pk_mul_f32 v[128:129], v[128:129], s[88:89]
    v_pk_mul_f32 v[130:131], v[130:131], s[88:89]
    v_pk_mul_f32 v[132:133], v[132:133], s[88:89]
    v_pk_mul_f32 v[134:135], v[134:135], s[88:89]
    v_pk_mul_f32 v[136:137], v[136:137], s[88:89]
    v_pk_mul_f32 v[138:139], v[138:139], s[88:89]
    v_pk_mul_f32 v[140:141], v[140:141], s[88:89]
    v_pk_mul_f32 v[142:143], v[142:143], s[88:89]
    v_mfma_f32_16x16x32_bf16 v[160:163], a[16:19], a[72:75], v[160:163]
    ds_read_b64_tr_b16 a[40:41], v46 offset:256
    ds_read_b64_tr_b16 a[42:43], v46 offset:2304
    v_mfma_f32_16x16x32_bf16 v[168:171], a[16:19], a[76:79], v[168:171]
    v_cvt_pk_bf16_f32 v64, v128, v129
    v_cvt_pk_bf16_f32 v65, v130, v131
    v_mfma_f32_16x16x32_bf16 v[164:167], a[20:23], a[72:75], v[164:167]
    ds_read_b64_tr_b16 a[44:45], v47 offset:256
    ds_read_b64_tr_b16 a[46:47], v47 offset:2304
    v_mfma_f32_16x16x32_bf16 v[172:175], a[20:23], a[76:79], v[172:175]
    s_waitcnt lgkmcnt(8)
    v_cvt_pk_bf16_f32 v66, v132, v133
    v_cvt_pk_bf16_f32 v67, v134, v135
    v_mfma_f32_16x16x32_bf16 v[176:179], a[24:27], a[72:75], v[176:179]
    ds_read_b64_tr_b16 a[48:49], v48 offset:256
    ds_read_b64_tr_b16 a[50:51], v48 offset:2304
    v_mfma_f32_16x16x32_bf16 v[184:187], a[24:27], a[76:79], v[184:187]
    v_cvt_pk_bf16_f32 v68, v136, v137
    v_cvt_pk_bf16_f32 v69, v138, v139
    v_cvt_pk_bf16_f32 v70, v140, v141
    v_cvt_pk_bf16_f32 v71, v142, v143
    v_permlane32_swap_b32 v64, v66
    v_permlane32_swap_b32 v65, v67
    v_permlane32_swap_b32 v68, v70
    v_permlane32_swap_b32 v69, v71
    v_permlane16_swap_b32 v64, v66
    v_permlane16_swap_b32 v65, v67
    v_permlane16_swap_b32 v68, v70
    v_permlane16_swap_b32 v69, v71
    v_pk_mul_f32 v[144:145], v[144:145], s[88:89]
    v_pk_mul_f32 v[146:147], v[146:147], s[88:89]
    v_pk_mul_f32 v[148:149], v[148:149], s[88:89]
    v_pk_mul_f32 v[150:151], v[150:151], s[88:89]
    v_pk_mul_f32 v[152:153], v[152:153], s[88:89]
    v_pk_mul_f32 v[154:155], v[154:155], s[88:89]
    v_pk_mul_f32 v[156:157], v[156:157], s[88:89]
    v_pk_mul_f32 v[158:159], v[158:159], s[88:89]
    v_mfma_f32_16x16x32_bf16 v[180:183], a[28:31], a[72:75], v[180:183]
    ds_read_b64_tr_b16 a[52:53], v49 offset:256
    ds_read_b64_tr_b16 a[54:55], v49 offset:2304
    v_mfma_f32_16x16x32_bf16 v[188:191], a[28:31], a[76:79], v[188:191]
    s_waitcnt lgkmcnt(8)
    v_cvt_pk_bf16_f32 v72, v144, v145
    v_cvt_pk_bf16_f32 v73, v146, v147
    v_mfma_f32_16x16x32_bf16 v[192:195], a[32:35], a[72:75], v[192:195]
    ds_read_b64_tr_b16 a[56:57], v50 offset:256
    ds_read_b64_tr_b16 a[58:59], v50 offset:2304
    v_mfma_f32_16x16x32_bf16 v[200:203], a[32:35], a[76:79], v[200:203]
    v_cvt_pk_bf16_f32 v74, v148, v149
    v_cvt_pk_bf16_f32 v75, v150, v151
    v_mfma_f32_16x16x32_bf16 v[196:199], a[36:39], a[72:75], v[196:199]
    ds_read_b64_tr_b16 a[60:61], v51 offset:256
    ds_read_b64_tr_b16 a[62:63], v51 offset:2304
    v_mfma_f32_16x16x32_bf16 v[204:207], a[36:39], a[76:79], v[204:207]
    s_waitcnt lgkmcnt(8)
    v_cvt_pk_bf16_f32 v76, v152, v153
    v_cvt_pk_bf16_f32 v77, v154, v155
    v_cvt_pk_bf16_f32 v78, v156, v157
    v_cvt_pk_bf16_f32 v79, v158, v159
    v_permlane32_swap_b32 v72, v74
    v_permlane32_swap_b32 v73, v75
    v_permlane32_swap_b32 v76, v78
    v_permlane32_swap_b32 v77, v79
    v_permlane16_swap_b32 v72, v74
    v_permlane16_swap_b32 v73, v75
    v_permlane16_swap_b32 v76, v78
    v_permlane16_swap_b32 v77, v79
    v_pk_mul_f32 v[160:161], v[160:161], s[88:89]
    v_pk_mul_f32 v[162:163], v[162:163], s[88:89]
    v_pk_mul_f32 v[164:165], v[164:165], s[88:89]
    v_pk_mul_f32 v[166:167], v[166:167], s[88:89]
    v_pk_mul_f32 v[168:169], v[168:169], s[88:89]
    v_pk_mul_f32 v[170:171], v[170:171], s[88:89]
    v_pk_mul_f32 v[172:173], v[172:173], s[88:89]
    v_pk_mul_f32 v[174:175], v[174:175], s[88:89]
    v_mfma_f32_16x16x32_bf16 v[208:211], a[40:43], a[72:75], v[208:211]
    s_barrier
    ds_read_b128 a[0:3], v40 offset:0
    v_cvt_pk_bf16_f32 v80, v160, v161
    v_mfma_f32_16x16x32_bf16 v[216:219], a[40:43], a[76:79], v[216:219]
    v_cvt_pk_bf16_f32 v81, v162, v163
    v_cvt_pk_bf16_f32 v82, v164, v165
    v_mfma_f32_16x16x32_bf16 v[212:215], a[44:47], a[72:75], v[212:215]
    ds_read_b128 a[4:7], v40 offset:8192
    v_cvt_pk_bf16_f32 v83, v166, v167
    v_mfma_f32_16x16x32_bf16 v[220:223], a[44:47], a[76:79], v[220:223]
    s_waitcnt lgkmcnt(6)
    v_cvt_pk_bf16_f32 v84, v168, v169
    v_cvt_pk_bf16_f32 v85, v170, v171
    v_mfma_f32_16x16x32_bf16 v[224:227], a[48:51], a[72:75], v[224:227]
    ds_read_b128 a[8:11], v41 offset:0
    v_cvt_pk_bf16_f32 v86, v172, v173
    v_mfma_f32_16x16x32_bf16 v[232:235], a[48:51], a[76:79], v[232:235]
    v_cvt_pk_bf16_f32 v87, v174, v175
    v_permlane32_swap_b32 v80, v82
    v_permlane32_swap_b32 v81, v83
    v_permlane32_swap_b32 v84, v86
    v_permlane32_swap_b32 v85, v87
    v_permlane16_swap_b32 v80, v82
    v_permlane16_swap_b32 v81, v83
    v_permlane16_swap_b32 v84, v86
    v_permlane16_swap_b32 v85, v87
    v_pk_mul_f32 v[176:177], v[176:177], s[88:89]
    v_pk_mul_f32 v[178:179], v[178:179], s[88:89]
    v_pk_mul_f32 v[180:181], v[180:181], s[88:89]
    v_pk_mul_f32 v[182:183], v[182:183], s[88:89]
    v_pk_mul_f32 v[184:185], v[184:185], s[88:89]
    v_pk_mul_f32 v[186:187], v[186:187], s[88:89]
    v_pk_mul_f32 v[188:189], v[188:189], s[88:89]
    v_pk_mul_f32 v[190:191], v[190:191], s[88:89]
    v_mfma_f32_16x16x32_bf16 v[228:231], a[52:55], a[72:75], v[228:231]
    ds_read_b128 a[12:15], v41 offset:8192
    v_cvt_pk_bf16_f32 v88, v176, v177
    v_mfma_f32_16x16x32_bf16 v[236:239], a[52:55], a[76:79], v[236:239]
    s_waitcnt lgkmcnt(4)
    v_cvt_pk_bf16_f32 v89, v178, v179
    v_cvt_pk_bf16_f32 v90, v180, v181
    v_mfma_f32_16x16x32_bf16 v[240:243], a[56:59], a[72:75], v[240:243]
    ds_read_b128 a[16:19], v42 offset:0
    v_cvt_pk_bf16_f32 v91, v182, v183
    v_mfma_f32_16x16x32_bf16 v[248:251], a[56:59], a[76:79], v[248:251]
    v_cvt_pk_bf16_f32 v92, v184, v185
    v_cvt_pk_bf16_f32 v93, v186, v187
    v_mfma_f32_16x16x32_bf16 v[244:247], a[60:63], a[72:75], v[244:247]
    ds_read_b128 a[20:23], v42 offset:8192
L_pg3:
    s_cbranch_execz L_warm_done
    v_cvt_pk_bf16_f32 v94, v188, v189
    v_mfma_f32_16x16x32_bf16 v[252:255], a[60:63], a[76:79], v[252:255]
    s_waitcnt lgkmcnt(4)
    v_cvt_pk_bf16_f32 v95, v190, v191
    v_permlane32_swap_b32 v88, v90
    v_permlane32_swap_b32 v89, v91
    v_permlane32_swap_b32 v92, v94
    v_permlane32_swap_b32 v93, v95
    v_permlane16_swap_b32 v88, v90
    v_permlane16_swap_b32 v89, v91
    v_permlane16_swap_b32 v92, v94
    v_permlane16_swap_b32 v93, v95
    v_pk_mul_f32 v[192:193], v[192:193], s[88:89]
    v_pk_mul_f32 v[194:195], v[194:195], s[88:89]
    v_pk_mul_f32 v[196:197], v[196:197], s[88:89]
    v_pk_mul_f32 v[198:199], v[198:199], s[88:89]
    v_pk_mul_f32 v[200:201], v[200:201], s[88:89]
    v_pk_mul_f32 v[202:203], v[202:203], s[88:89]
    v_pk_mul_f32 v[204:205], v[204:205], s[88:89]
    v_pk_mul_f32 v[206:207], v[206:207], s[88:89]
    v_mfma_f32_16x16x32_bf16 v[0:3], a[0:3], v[64:67], v[52:55]
    ds_read_b128 a[24:27], v43 offset:0
    v_cvt_pk_bf16_f32 v96, v192, v193
    v_mfma_f32_16x16x32_bf16 v[8:11], a[0:3], v[68:71], v[56:59]
    v_cvt_pk_bf16_f32 v97, v194, v195
    v_cvt_pk_bf16_f32 v98, v196, v197
    v_mfma_f32_16x16x32_bf16 v[4:7], a[4:7], v[64:67], v[52:55]
    ds_read_b128 a[28:31], v43 offset:8192
    v_cvt_pk_bf16_f32 v99, v198, v199
    v_mfma_f32_16x16x32_bf16 v[12:15], a[4:7], v[68:71], v[56:59]
    s_waitcnt lgkmcnt(4)
    v_cvt_pk_bf16_f32 v100, v200, v201
    v_cvt_pk_bf16_f32 v101, v202, v203
    v_mfma_f32_16x16x32_bf16 v[0:3], a[8:11], v[72:75], v[0:3]
    ds_read_b128 a[32:35], v40 offset:256
    v_cvt_pk_bf16_f32 v102, v204, v205
    v_mfma_f32_16x16x32_bf16 v[8:11], a[8:11], v[76:79], v[8:11]
    v_cvt_pk_bf16_f32 v103, v206, v207
    v_permlane32_swap_b32 v96, v98
    v_permlane32_swap_b32 v97, v99
    v_permlane32_swap_b32 v100, v102
    v_permlane32_swap_b32 v101, v103
    v_permlane16_swap_b32 v96, v98
    v_permlane16_swap_b32 v97, v99
    v_permlane16_swap_b32 v100, v102
    v_permlane16_swap_b32 v101, v103
    v_pk_mul_f32 v[208:209], v[208:209], s[88:89]
    v_pk_mul_f32 v[210:211], v[210:211], s[88:89]
    v_pk_mul_f32 v[212:213], v[212:213], s[88:89]
    v_pk_mul_f32 v[214:215], v[214:215], s[88:89]
    v_pk_mul_f32 v[216:217], v[216:217], s[88:89]
    v_pk_mul_f32 v[218:219], v[218:219], s[88:89]
    v_pk_mul_f32 v[220:221], v[220:221], s[88:89]
    v_pk_mul_f32 v[222:223], v[222:223], s[88:89]
    v_mfma_f32_16x16x32_bf16 v[4:7], a[12:15], v[72:75], v[4:7]
    ds_read_b128 a[36:39], v40 offset:8448
    v_cvt_pk_bf16_f32 v104, v208, v209
    v_mfma_f32_16x16x32_bf16 v[12:15], a[12:15], v[76:79], v[12:15]
    s_waitcnt lgkmcnt(4)
    v_accvgpr_read_b32 v40, a80
    v_add_u32 v40, 16384, v40
    v_mfma_f32_16x16x32_bf16 v[0:3], a[16:19], v[80:83], v[0:3]
    ds_read_b128 a[40:43], v41 offset:256
    v_cvt_pk_bf16_f32 v105, v210, v211
    v_mfma_f32_16x16x32_bf16 v[8:11], a[16:19], v[84:87], v[8:11]
    v_cvt_pk_bf16_f32 v106, v212, v213
    v_cvt_pk_bf16_f32 v107, v214, v215
    v_mfma_f32_16x16x32_bf16 v[4:7], a[20:23], v[80:83], v[4:7]
    ds_read_b128 a[44:47], v41 offset:8448
    v_cvt_pk_bf16_f32 v108, v216, v217
    v_mfma_f32_16x16x32_bf16 v[12:15], a[20:23], v[84:87], v[12:15]
    s_waitcnt lgkmcnt(4)
    v_xor_b32 v41, 64, v40
    v_cvt_pk_bf16_f32 v109, v218, v219
    v_cvt_pk_bf16_f32 v110, v220, v221
    v_cvt_pk_bf16_f32 v111, v222, v223
    v_permlane32_swap_b32 v104, v106
    v_permlane32_swap_b32 v105, v107
    v_permlane32_swap_b32 v108, v110
    v_permlane32_swap_b32 v109, v111
    v_permlane16_swap_b32 v104, v106
    v_permlane16_swap_b32 v105, v107
    v_permlane16_swap_b32 v108, v110
    v_permlane16_swap_b32 v109, v111
    v_pk_mul_f32 v[224:225], v[224:225], s[88:89]
    v_pk_mul_f32 v[226:227], v[226:227], s[88:89]
    v_pk_mul_f32 v[228:229], v[228:229], s[88:89]
    v_pk_mul_f32 v[230:231], v[230:231], s[88:89]
    v_pk_mul_f32 v[232:233], v[232:233], s[88:89]
    v_pk_mul_f32 v[234:235], v[234:235], s[88:89]
    v_pk_mul_f32 v[236:237], v[236:237], s[88:89]
    v_pk_mul_f32 v[238:239], v[238:239], s[88:89]
    v_mfma_f32_16x16x32_bf16 v[0:3], a[24:27], v[88:91], v[0:3]
    ds_read_b128 a[48:51], v42 offset:256
    v_cvt_pk_bf16_f32 v112, v224, v225
    v_mfma_f32_16x16x32_bf16 v[8:11], a[24:27], v[92:95], v[8:11]
    v_cvt_pk_bf16_f32 v113, v226, v227
    v_cvt_pk_bf16_f32 v114, v228, v229
    v_mfma_f32_16x16x32_bf16 v[4:7], a[28:31], v[88:91], v[4:7]
    ds_read_b128 a[52:55], v42 offset:8448
    v_cvt_pk_bf16_f32 v115, v230, v231
    v_mfma_f32_16x16x32_bf16 v[12:15], a[28:31], v[92:95], v[12:15]
    s_waitcnt lgkmcnt(4)
    v_xor_b32 v42, 128, v40
    v_cvt_pk_bf16_f32 v116, v232, v233
    v_mfma_f32_16x16x32_bf16 v[0:3], a[32:35], v[96:99], v[0:3]
    ds_read_b128 a[56:59], v43 offset:256
    v_cvt_pk_bf16_f32 v117, v234, v235
    v_mfma_f32_16x16x32_bf16 v[8:11], a[32:35], v[100:103], v[8:11]
    v_cvt_pk_bf16_f32 v118, v236, v237
    v_cvt_pk_bf16_f32 v119, v238, v239
    v_permlane32_swap_b32 v112, v114
    v_permlane32_swap_b32 v113, v115
    v_permlane32_swap_b32 v116, v118
    v_permlane32_swap_b32 v117, v119
    v_permlane16_swap_b32 v112, v114
    v_permlane16_swap_b32 v113, v115
    v_permlane16_swap_b32 v116, v118
    v_permlane16_swap_b32 v117, v119
    v_pk_mul_f32 v[240:241], v[240:241], s[88:89]
    v_pk_mul_f32 v[242:243], v[242:243], s[88:89]
    v_pk_mul_f32 v[244:245], v[244:245], s[88:89]
    v_pk_mul_f32 v[246:247], v[246:247], s[88:89]
    v_pk_mul_f32 v[248:249], v[248:249], s[88:89]
    v_pk_mul_f32 v[250:251], v[250:251], s[88:89]
    v_pk_mul_f32 v[252:253], v[252:253], s[88:89]
    v_pk_mul_f32 v[254:255], v[254:255], s[88:89]
    v_mfma_f32_16x16x32_bf16 v[4:7], a[36:39], v[96:99], v[4:7]
    ds_read_b128 a[60:63], v43 offset:8448
    v_cvt_pk_bf16_f32 v120, v240, v241
    v_mfma_f32_16x16x32_bf16 v[12:15], a[36:39], v[100:103], v[12:15]
    s_waitcnt lgkmcnt(4)
    v_xor_b32 v43, 192, v40
    v_cvt_pk_bf16_f32 v121, v242, v243
    v_mfma_f32_16x16x32_bf16 v[0:3], a[40:43], v[104:107], v[0:3]
    s_barrier
    ds_read_b128 a[0:3], v40 offset:0
    v_cvt_pk_bf16_f32 v122, v244, v245
    v_cvt_pk_bf16_f32 v123, v246, v247
    v_mfma_f32_16x16x32_bf16 v[8:11], a[40:43], v[108:111], v[8:11]
    v_cvt_pk_bf16_f32 v124, v248, v249
    v_cvt_pk_bf16_f32 v125, v250, v251
    v_mfma_f32_16x16x32_bf16 v[4:7], a[44:47], v[104:107], v[4:7]
    ds_read_b128 a[4:7], v41 offset:0
    v_cvt_pk_bf16_f32 v126, v252, v253
    v_cvt_pk_bf16_f32 v127, v254, v255
    v_mfma_f32_16x16x32_bf16 v[12:15], a[44:47], v[108:111], v[12:15]
    s_waitcnt lgkmcnt(4)
    v_permlane32_swap_b32 v120, v122
    v_permlane32_swap_b32 v121, v123
    v_mfma_f32_16x16x32_bf16 v[0:3], a[48:51], v[112:115], v[0:3]
    ds_read_b128 a[8:11], v42 offset:0
    v_permlane32_swap_b32 v124, v126
    v_permlane32_swap_b32 v125, v127
    v_mfma_f32_16x16x32_bf16 v[8:11], a[48:51], v[116:119], v[8:11]
    v_permlane16_swap_b32 v120, v122
    v_permlane16_swap_b32 v121, v123
    v_mfma_f32_16x16x32_bf16 v[4:7], a[52:55], v[112:115], v[4:7]
    ds_read_b128 a[12:15], v43 offset:0
    v_permlane16_swap_b32 v124, v126
    v_permlane16_swap_b32 v125, v127
    v_mfma_f32_16x16x32_bf16 v[12:15], a[52:55], v[116:119], v[12:15]
    s_waitcnt lgkmcnt(4)
    v_mfma_f32_16x16x32_bf16 v[0:3], a[56:59], v[120:123], v[0:3]
    ds_read_b128 a[16:19], v40 offset:256
    v_mfma_f32_16x16x32_bf16 v[8:11], a[56:59], v[124:127], v[8:11]
    v_mfma_f32_16x16x32_bf16 v[4:7], a[60:63], v[120:123], v[4:7]
    ds_read_b128 a[20:23], v41 offset:256
    v_mfma_f32_16x16x32_bf16 v[12:15], a[60:63], v[124:127], v[12:15]
    s_waitcnt lgkmcnt(4)
    s_nop 5
    v_max3_f32 v62, v0, v1, v2
    v_max3_f32 v63, v8, v9, v10
    v_max3_f32 v62, v62, v3, v4
    v_max3_f32 v63, v63, v11, v12
    v_max3_f32 v62, v62, v5, v6
    v_max3_f32 v63, v63, v13, v14
    v_max_f32 v62, v62, v7
    v_max_f32 v63, v63, v15
    v_mov_b32 v34, v62
    v_mov_b32 v35, v63
    s_nop 1
    v_permlane32_swap_b32 v62, v34
    v_permlane32_swap_b32 v63, v35
    v_max_f32 v62, v62, v34
    v_max_f32 v63, v63, v35
    v_mov_b32 v34, v62
    v_mov_b32 v35, v63
    s_nop 1
    v_permlane16_swap_b32 v62, v34
    v_permlane16_swap_b32 v63, v35
    v_max_f32 v62, v62, v34
    v_max_f32 v63, v63, v35
    v_sub_f32 v16, v0, v62
    v_sub_f32 v17, v1, v62
    v_sub_f32 v18, v2, v62
    v_sub_f32 v19, v3, v62
    v_sub_f32 v20, v4, v62
    v_sub_f32 v21, v5, v62
    v_sub_f32 v22, v6, v62
    v_sub_f32 v23, v7, v62
    v_sub_f32 v24, v8, v63
    v_sub_f32 v25, v9, v63
    v_sub_f32 v26, v10, v63
    v_sub_f32 v27, v11, v63
    v_sub_f32 v28, v12, v63
    v_sub_f32 v29, v13, v63
    v_sub_f32 v30, v14, v63
    v_sub_f32 v31, v15, v63
    v_sub_f32 v52, v52, v62
    v_sub_f32 v53, v53, v62
    v_sub_f32 v54, v54, v62
    v_sub_f32 v55, v55, v62
    v_sub_f32 v56, v56, v63
    v_sub_f32 v57, v57, v63
    v_sub_f32 v58, v58, v63
    v_sub_f32 v59, v59, v63
    s_nop 0
    v_mfma_f32_16x16x32_bf16 v[0:3], a[0:3], v[64:67], v[52:55]
    ds_read_b128 a[24:27], v42 offset:256
    v_mfma_f32_16x16x32_bf16 v[0:3], a[4:7], v[72:75], v[0:3]
    s_waitcnt lgkmcnt(3)
    v_exp_f32 v16, v16
    v_mfma_f32_16x16x32_bf16 v[0:3], a[8:11], v[80:83], v[0:3]
    ds_read_b128 a[28:31], v43 offset:256
    v_exp_f32 v24, v24
    v_mfma_f32_16x16x32_bf16 v[0:3], a[12:15], v[88:91], v[0:3]
    v_exp_f32 v17, v17
    v_exp_f32 v25, v25
    v_mfma_f32_16x16x32_bf16 v[8:11], a[0:3], v[68:71], v[56:59]
    ds_read_b128 a[32:35], v40 offset:8192
    v_exp_f32 v18, v18
    v_mfma_f32_16x16x32_bf16 v[8:11], a[4:7], v[76:79], v[8:11]
    v_exp_f32 v26, v26
    v_add_f32 v62, v16, v17
    v_mfma_f32_16x16x32_bf16 v[8:11], a[8:11], v[84:87], v[8:11]
    ds_read_b128 a[36:39], v41 offset:8192
    v_exp_f32 v19, v19
    v_mfma_f32_16x16x32_bf16 v[8:11], a[12:15], v[92:95], v[8:11]
    s_waitcnt lgkmcnt(4)
    v_accvgpr_read_b32 v44, a81
    v_add_u32 v44, 32768, v44
    v_xor_b32 v45, 32, v44
    v_mfma_f32_16x16x32_bf16 v[0:3], a[16:19], v[96:99], v[0:3]
    ds_read_b128 a[40:43], v42 offset:8192
    v_xor_b32 v46, 64, v44
    v_mfma_f32_16x16x32_bf16 v[0:3], a[20:23], v[104:107], v[0:3]
    s_waitcnt lgkmcnt(3)
    v_xor_b32 v47, 96, v44
    v_xor_b32 v48, 128, v44
    v_add_f32 v63, v24, v25
    v_mfma_f32_16x16x32_bf16 v[0:3], a[24:27], v[112:115], v[0:3]
    ds_read_b128 a[44:47], v43 offset:8192
    v_exp_f32 v27, v27
    v_mfma_f32_16x16x32_bf16 v[0:3], a[28:31], v[120:123], v[0:3]
    v_add_f32 v62, v62, v18
    v_exp_f32 v20, v20
    v_mfma_f32_16x16x32_bf16 v[8:11], a[16:19], v[100:103], v[8:11]
    ds_read_b128 a[48:51], v40 offset:8448
    v_add_f32 v63, v63, v26
    v_xor_b32 v49, 160, v44
    v_mfma_f32_16x16x32_bf16 v[8:11], a[20:23], v[108:111], v[8:11]
    v_exp_f32 v28, v28
    v_add_f32 v62, v62, v19
    v_mfma_f32_16x16x32_bf16 v[8:11], a[24:27], v[116:119], v[8:11]
    ds_read_b128 a[52:55], v41 offset:8448
    v_exp_f32 v21, v21
    v_mfma_f32_16x16x32_bf16 v[8:11], a[28:31], v[124:127], v[8:11]
    s_waitcnt lgkmcnt(4)
    v_add_f32 v63, v63, v27
    v_exp_f32 v29, v29
    v_mfma_f32_16x16x32_bf16 v[4:7], a[32:35], v[64:67], v[52:55]
    ds_read_b128 a[56:59], v42 offset:8448
    v_add_f32 v62, v62, v20
    v_mfma_f32_16x16x32_bf16 v[4:7], a[36:39], v[72:75], v[4:7]
    s_waitcnt lgkmcnt(3)
    v_exp_f32 v22, v22
    v_add_f32 v63, v63, v28
    v_mfma_f32_16x16x32_bf16 v[4:7], a[40:43], v[80:83], v[4:7]
    ds_read_b128 a[60:63], v43 offset:8448
    v_exp_f32 v30, v30
    v_mfma_f32_16x16x32_bf16 v[4:7], a[44:47], v[88:91], v[4:7]
    v_add_f32 v62, v62, v21
    v_exp_f32 v23, v23
    v_mfma_f32_16x16x32_bf16 v[12:15], a[32:35], v[68:71], v[56:59]
    s_barrier
    ds_read_b64_tr_b16 a[0:1], v44 offset:0
    ds_read_b64_tr_b16 a[2:3], v44 offset:8192
    v_add_f32 v63, v63, v29
    v_mfma_f32_16x16x32_bf16 v[12:15], a[36:39], v[76:79], v[12:15]
    v_exp_f32 v31, v31
    v_add_f32 v62, v62, v22
    v_mfma_f32_16x16x32_bf16 v[12:15], a[40:43], v[84:87], v[12:15]
    ds_read_b64_tr_b16 a[4:5], v45 offset:0
    ds_read_b64_tr_b16 a[6:7], v45 offset:8192
    v_add_f32 v63, v63, v30
    v_mfma_f32_16x16x32_bf16 v[12:15], a[44:47], v[92:95], v[12:15]
    s_waitcnt lgkmcnt(6)
    v_add_f32 v62, v62, v23
    v_add_f32 v63, v63, v31
    v_add_f32 v60, v60, v62
    v_mfma_f32_16x16x32_bf16 v[4:7], a[48:51], v[96:99], v[4:7]
    ds_read_b64_tr_b16 a[8:9], v46 offset:0
    ds_read_b64_tr_b16 a[10:11], v46 offset:8192
    v_mfma_f32_16x16x32_bf16 v[4:7], a[52:55], v[104:107], v[4:7]
    s_waitcnt lgkmcnt(6)
    v_add_f32 v61, v61, v63
    v_cvt_pk_bf16_f32 v32, v16, v17
    v_cvt_pk_bf16_f32 v33, v18, v19
    v_mfma_f32_16x16x32_bf16 v[4:7], a[56:59], v[112:115], v[4:7]
    ds_read_b64_tr_b16 a[12:13], v47 offset:0
    ds_read_b64_tr_b16 a[14:15], v47 offset:8192
    v_cvt_pk_bf16_f32 v34, v20, v21
    v_mfma_f32_16x16x32_bf16 v[4:7], a[60:63], v[120:123], v[4:7]
    v_cvt_pk_bf16_f32 v35, v22, v23
    v_cvt_pk_bf16_f32 v36, v24, v25
    v_cvt_pk_bf16_f32 v37, v26, v27
    v_mfma_f32_16x16x32_bf16 v[12:15], a[48:51], v[100:103], v[12:15]
    ds_read_b64_tr_b16 a[16:17], v48 offset:0
    ds_read_b64_tr_b16 a[18:19], v48 offset:8192
    v_cvt_pk_bf16_f32 v38, v28, v29
    v_mfma_f32_16x16x32_bf16 v[12:15], a[52:55], v[108:111], v[12:15]
    v_cvt_pk_bf16_f32 v39, v30, v31
    v_xor_b32 v50, 192, v44
    v_xor_b32 v51, 224, v44
    v_mfma_f32_16x16x32_bf16 v[12:15], a[56:59], v[116:119], v[12:15]
    ds_read_b64_tr_b16 a[20:21], v49 offset:0
    ds_read_b64_tr_b16 a[22:23], v49 offset:8192
    v_mfma_f32_16x16x32_bf16 v[12:15], a[60:63], v[124:127], v[12:15]
    s_waitcnt lgkmcnt(8)
    v_mfma_f32_16x16x32_bf16 v[128:131], a[0:3], v[32:35], 0
    ds_read_b64_tr_b16 a[24:25], v50 offset:0
    ds_read_b64_tr_b16 a[26:27], v50 offset:8192
    v_mfma_f32_16x16x32_bf16 v[136:139], a[0:3], v[36:39], 0
    v_mfma_f32_16x16x32_bf16 v[132:135], a[4:7], v[32:35], 0
    ds_read_b64_tr_b16 a[28:29], v51 offset:0
    ds_read_b64_tr_b16 a[30:31], v51 offset:8192
    v_mfma_f32_16x16x32_bf16 v[140:143], a[4:7], v[36:39], 0
    s_waitcnt lgkmcnt(8)
    v_exp_f32 v16, v0
    v_exp_f32 v24, v8
    v_mfma_f32_16x16x32_bf16 v[144:147], a[8:11], v[32:35], 0
    ds_read_b64_tr_b16 a[32:33], v44 offset:256
    ds_read_b64_tr_b16 a[34:35], v44 offset:8448
    v_mfma_f32_16x16x32_bf16 v[152:155], a[8:11], v[36:39], 0
    v_exp_f32 v17, v1
    v_mfma_f32_16x16x32_bf16 v[148:151], a[12:15], v[32:35], 0
    ds_read_b64_tr_b16 a[36:37], v45 offset:256
    ds_read_b64_tr_b16 a[38:39], v45 offset:8448
    v_exp_f32 v25, v9
    v_mfma_f32_16x16x32_bf16 v[156:159], a[12:15], v[36:39], 0
    s_waitcnt lgkmcnt(8)
    v_accvgpr_read_b32 v40, a80
    v_add_u32 v40, 49152, v40
    v_xor_b32 v41, 64, v40
    v_mfma_f32_16x16x32_bf16 v[160:163], a[16:19], v[32:35], 0
    ds_read_b64_tr_b16 a[40:41], v46 offset:256
    ds_read_b64_tr_b16 a[42:43], v46 offset:8448
    v_mfma_f32_16x16x32_bf16 v[168:171], a[16:19], v[36:39], 0
    v_xor_b32 v42, 128, v40
    v_xor_b32 v43, 192, v40
    v_mfma_f32_16x16x32_bf16 v[164:167], a[20:23], v[32:35], 0
    ds_read_b64_tr_b16 a[44:45], v47 offset:256
    ds_read_b64_tr_b16 a[46:47], v47 offset:8448
    v_exp_f32 v18, v2
    v_mfma_f32_16x16x32_bf16 v[172:175], a[20:23], v[36:39], 0
    s_waitcnt lgkmcnt(8)
    v_exp_f32 v26, v10
    v_mfma_f32_16x16x32_bf16 v[176:179], a[24:27], v[32:35], 0
    ds_read_b64_tr_b16 a[48:49], v48 offset:256
    ds_read_b64_tr_b16 a[50:51], v48 offset:8448
    v_add_f32 v62, v16, v17
    v_mfma_f32_16x16x32_bf16 v[184:187], a[24:27], v[36:39], 0
    v_exp_f32 v19, v3
    v_add_f32 v63, v24, v25
    v_mfma_f32_16x16x32_bf16 v[180:183], a[28:31], v[32:35], 0
    ds_read_b64_tr_b16 a[52:53], v49 offset:256
    ds_read_b64_tr_b16 a[54:55], v49 offset:8448
    v_mfma_f32_16x16x32_bf16 v[188:191], a[28:31], v[36:39], 0
    s_waitcnt lgkmcnt(8)
    v_exp_f32 v27, v11
    v_add_f32 v62, v62, v18
    v_mfma_f32_16x16x32_bf16 v[192:195], a[32:35], v[32:35], 0
    ds_read_b64_tr_b16 a[56:57], v50 offset:256
    ds_read_b64_tr_b16 a[58:59], v50 offset:8448
    v_mfma_f32_16x16x32_bf16 v[200:203], a[32:35], v[36:39], 0
    v_exp_f32 v20, v4
    v_add_f32 v63, v63, v26
    v_mfma_f32_16x16x32_bf16 v[196:199], a[36:39], v[32:35], 0
    ds_read_b64_tr_b16 a[60:61], v51 offset:256
    ds_read_b64_tr_b16 a[62:63], v51 offset:8448
    v_mfma_f32_16x16x32_bf16 v[204:207], a[36:39], v[36:39], 0
    s_waitcnt lgkmcnt(8)
    v_exp_f32 v28, v12
    v_add_f32 v62, v62, v19
    v_mfma_f32_16x16x32_bf16 v[208:211], a[40:43], v[32:35], 0
    s_barrier
    ds_read_b128 a[0:3], v40 offset:0
    v_exp_f32 v21, v5
    v_mfma_f32_16x16x32_bf16 v[216:219], a[40:43], v[36:39], 0
    v_add_f32 v63, v63, v27
    v_exp_f32 v29, v13
    v_mfma_f32_16x16x32_bf16 v[212:215], a[44:47], v[32:35], 0
    ds_read_b128 a[4:7], v41 offset:0
    v_add_f32 v62, v62, v20
    v_mfma_f32_16x16x32_bf16 v[220:223], a[44:47], v[36:39], 0
    s_waitcnt lgkmcnt(6)
    v_exp_f32 v22, v6
    v_add_f32 v63, v63, v28
    v_mfma_f32_16x16x32_bf16 v[224:227], a[48:51], v[32:35], 0
    ds_read_b128 a[8:11], v42 offset:0
    v_exp_f32 v30, v14
    v_mfma_f32_16x16x32_bf16 v[232:235], a[48:51], v[36:39], 0
    v_add_f32 v62, v62, v21
    v_exp_f32 v23, v7
    v_mfma_f32_16x16x32_bf16 v[228:231], a[52:55], v[32:35], 0
    ds_read_b128 a[12:15], v43 offset:0
    v_add_f32 v63, v63, v29
    v_mfma_f32_16x16x32_bf16 v[236:239], a[52:55], v[36:39], 0
    s_waitcnt lgkmcnt(4)
    v_exp_f32 v31, v15
    v_add_f32 v62, v62, v22
    v_mfma_f32_16x16x32_bf16 v[240:243], a[56:59], v[32:35], 0
    ds_read_b128 a[16:19], v40 offset:256
    v_add_f32 v63, v63, v30
    v_add_f32 v62, v62, v23
    v_mfma_f32_16x16x32_bf16 v[248:251], a[56:59], v[36:39], 0
    v_add_f32 v63, v63, v31
    v_max_f32 v51, v62, v63
    v_mfma_f32_16x16x32_bf16 v[244:247], a[60:63], v[32:35], 0
    ds_read_b128 a[20:23], v41 offset:256
    v_cmp_lt_f32 vcc, s61, v51
    v_mfma_f32_16x16x32_bf16 v[252:255], a[60:63], v[36:39], 0
    s_waitcnt lgkmcnt(4)
    s_cbranch_vccnz L_rare_a
L_rare_ret_a:
    s_mov_b32 s62, 32768
    s_mov_b32 s64, 28
    s_mov_b32 s58, 32768
    s_mov_b32 s59, -131072
    s_branch L_pgs4
.p2align 12
L_pgs4:
L_pg4:
    s_cbranch_execz L_w2_0
L_loop:
    v_mfma_f32_16x16x32_bf16 v[0:3], a[0:3], v[64:67], v[52:55]
    s_add_u32 s62, s62, s58
    ds_read_b128 a[24:27], v42 offset:256
    v_add_f32 v60, v60, v62
    v_mfma_f32_16x16x32_bf16 v[0:3], a[4:7], v[72:75], v[0:3]
    s_waitcnt lgkmcnt(3)
    v_add_f32 v61, v61, v63
    v_cvt_pk_bf16_f32 v32, v16, v17
    v_mfma_f32_16x16x32_bf16 v[0:3], a[8:11], v[80:83], v[0:3]
    s_cmp_eq_u32 s62, 163840
    ds_read_b128 a[28:31], v43 offset:256
    v_cvt_pk_bf16_f32 v33, v18, v19
    v_mfma_f32_16x16x32_bf16 v[0:3], a[12:15], v[88:91], v[0:3]
    s_cselect_b32 s63, s59, s58
    v_cvt_pk_bf16_f32 v34, v20, v21
    v_cvt_pk_bf16_f32 v35, v22, v23
    v_mfma_f32_16x16x32_bf16 v[8:11], a[0:3], v[68:71], v[56:59]
    s_cselect_b32 s62, 0, s62
    ds_read_b128 a[32:35], v40 offset:8192
    v_cvt_pk_bf16_f32 v36, v24, v25
    v_mfma_f32_16x16x32_bf16 v[8:11], a[4:7], v[76:79], v[8:11]
    v_cvt_pk_bf16_f32 v37, v26, v27
    v_cvt_pk_bf16_f32 v38, v28, v29
    v_mfma_f32_16x16x32_bf16 v[8:11], a[8:11], v[84:87], v[8:11]
    ds_read_b128 a[36:39], v41 offset:8192
    v_cvt_pk_bf16_f32 v39, v30, v31
    v_mfma_f32_16x16x32_bf16 v[8:11], a[12:15], v[92:95], v[8:11]
    s_waitcnt lgkmcnt(4)
    v_add_u32 v44, s63, v44
    v_xor_b32 v45, 32, v44
    v_xor_b32 v46, 64, v44
    v_mfma_f32_16x16x32_bf16 v[0:3], a[16:19], v[96:99], v[0:3]
    ds_read_b128 a[40:43], v42 offset:8192
    v_xor_b32 v47, 96, v44
    v_mfma_f32_16x16x32_bf16 v[0:3], a[20:23], v[104:107], v[0:3]
    s_waitcnt lgkmcnt(3)
    v_xor_b32 v48, 128, v44
    v_xor_b32 v49, 160, v44
    v_mfma_f32_16x16x32_bf16 v[0:3], a[24:27], v[112:115], v[0:3]
    ds_read_b128 a[44:47], v43 offset:8192
    v_xor_b32 v50, 192, v44
    v_mfma_f32_16x16x32_bf16 v[0:3], a[28:31], v[120:123], v[0:3]
    v_xor_b32 v51, 224, v44
    v_mfma_f32_16x16x32_bf16 v[8:11], a[16:19], v[100:103], v[8:11]
    ds_read_b128 a[48:51], v40 offset:8448
    v_mfma_f32_16x16x32_bf16 v[8:11], a[20:23], v[108:111], v[8:11]
    v_mfma_f32_16x16x32_bf16 v[8:11], a[24:27], v[116:119], v[8:11]
    ds_read_b128 a[52:55], v41 offset:8448
    v_mfma_f32_16x16x32_bf16 v[8:11], a[28:31], v[124:127], v[8:11]
    s_waitcnt lgkmcnt(4)
    v_mfma_f32_16x16x32_bf16 v[4:7], a[32:35], v[64:67], v[52:55]
    ds_read_b128 a[56:59], v42 offset:8448
    v_mfma_f32_16x16x32_bf16 v[4:7], a[36:39], v[72:75], v[4:7]
    s_waitcnt lgkmcnt(3)
    v_mfma_f32_16x16x32_bf16 v[4:7], a[40:43], v[80:83], v[4:7]
    ds_read_b128 a[60:63], v43 offset:8448
    v_mfma_f32_16x16x32_bf16 v[4:7], a[44:47], v[88:91], v[4:7]
    v_exp_f32 v16, v0
    v_mfma_f32_16x16x32_bf16 v[12:15], a[32:35], v[68:71], v[56:59]
    s_barrier
    ds_read_b64_tr_b16 a[0:1], v44 offset:0
    ds_read_b64_tr_b16 a[2:3], v44 offset:8192
    v_mfma_f32_16x16x32_bf16 v[12:15], a[36:39], v[76:79], v[12:15]
    v_exp_f32 v24, v8
    v_exp_f32 v17, v1
    v_mfma_f32_16x16x32_bf16 v[12:15], a[40:43], v[84:87], v[12:15]
    ds_read_b64_tr_b16 a[4:5], v45 offset:0
    ds_read_b64_tr_b16 a[6:7], v45 offset:8192
    v_mfma_f32_16x16x32_bf16 v[12:15], a[44:47], v[92:95], v[12:15]
    s_waitcnt lgkmcnt(6)
    v_exp_f32 v25, v9
    v_mfma_f32_16x16x32_bf16 v[4:7], a[48:51], v[96:99], v[4:7]
    ds_read_b64_tr_b16 a[8:9], v46 offset:0
    ds_read_b64_tr_b16 a[10:11], v46 offset:8192
    v_mfma_f32_16x16x32_bf16 v[4:7], a[52:55], v[104:107], v[4:7]
    s_waitcnt lgkmcnt(6)
    v_exp_f32 v18, v2
    v_mfma_f32_16x16x32_bf16 v[4:7], a[56:59], v[112:115], v[4:7]
    ds_read_b64_tr_b16 a[12:13], v47 offset:0
    ds_read_b64_tr_b16 a[14:15], v47 offset:8192
    v_mfma_f32_16x16x32_bf16 v[4:7], a[60:63], v[120:123], v[4:7]
    v_exp_f32 v26, v10
    v_mfma_f32_16x16x32_bf16 v[12:15], a[48:51], v[100:103], v[12:15]
    ds_read_b64_tr_b16 a[16:17], v48 offset:0
    ds_read_b64_tr_b16 a[18:19], v48 offset:8192
    v_add_f32 v62, v16, v17
    v_mfma_f32_16x16x32_bf16 v[12:15], a[52:55], v[108:111], v[12:15]
    v_exp_f32 v19, v3
    v_mfma_f32_16x16x32_bf16 v[12:15], a[56:59], v[116:119], v[12:15]
    ds_read_b64_tr_b16 a[20:21], v49 offset:0
    ds_read_b64_tr_b16 a[22:23], v49 offset:8192
    v_mfma_f32_16x16x32_bf16 v[12:15], a[60:63], v[124:127], v[12:15]
    s_waitcnt lgkmcnt(8)
    v_add_f32 v63, v24, v25
    v_mfma_f32_16x16x32_bf16 v[128:131], a[0:3], v[32:35], v[128:131]
    ds_read_b64_tr_b16 a[24:25], v50 offset:0
    ds_read_b64_tr_b16 a[26:27], v50 offset:8192
    v_mfma_f32_16x16x32_bf16 v[136:139], a[0:3], v[36:39], v[136:139]
    v_exp_f32 v27, v11
    v_mfma_f32_16x16x32_bf16 v[132:135], a[4:7], v[32:35], v[132:135]
    ds_read_b64_tr_b16 a[28:29], v51 offset:0
    ds_read_b64_tr_b16 a[30:31], v51 offset:8192
    v_mfma_f32_16x16x32_bf16 v[140:143], a[4:7], v[36:39], v[140:143]
    s_waitcnt lgkmcnt(8)
    v_add_f32 v62, v62, v18
    v_exp_f32 v20, v4
    v_mfma_f32_16x16x32_bf16 v[144:147], a[8:11], v[32:35], v[144:147]
    ds_read_b64_tr_b16 a[32:33], v44 offset:256
    ds_read_b64_tr_b16 a[34:35], v44 offset:8448
    v_mfma_f32_16x16x32_bf16 v[152:155], a[8:11], v[36:39], v[152:155]
    v_add_f32 v63, v63, v26
    v_mfma_f32_16x16x32_bf16 v[148:151], a[12:15], v[32:35], v[148:151]
    ds_read_b64_tr_b16 a[36:37], v45 offset:256
    ds_read_b64_tr_b16 a[38:39], v45 offset:8448
    v_mfma_f32_16x16x32_bf16 v[156:159], a[12:15], v[36:39], v[156:159]
    s_waitcnt lgkmcnt(8)
    v_add_u32 v40, s63, v40
    v_xor_b32 v41, 64, v40
    v_mfma_f32_16x16x32_bf16 v[160:163], a[16:19], v[32:35], v[160:163]
    ds_read_b64_tr_b16 a[40:41], v46 offset:256
    ds_read_b64_tr_b16 a[42:43], v46 offset:8448
    v_mfma_f32_16x16x32_bf16 v[168:171], a[16:19], v[36:39], v[168:171]
    v_xor_b32 v42, 128, v40
    v_xor_b32 v43, 192, v40
    v_mfma_f32_16x16x32_bf16 v[164:167], a[20:23], v[32:35], v[164:167]
    ds_read_b64_tr_b16 a[44:45], v47 offset:256
    ds_read_b64_tr_b16 a[46:47], v47 offset:8448
    v_mfma_f32_16x16x32_bf16 v[172:175], a[20:23], v[36:39], v[172:175]
    s_waitcnt lgkmcnt(8)
    v_exp_f32 v28, v12
    v_add_f32 v62, v62, v19
    v_mfma_f32_16x16x32_bf16 v[176:179], a[24:27], v[32:35], v[176:179]
    ds_read_b64_tr_b16 a[48:49], v48 offset:256
    ds_read_b64_tr_b16 a[50:51], v48 offset:8448
    v_mfma_f32_16x16x32_bf16 v[184:187], a[24:27], v[36:39], v[184:187]
    v_exp_f32 v21, v5
    v_mfma_f32_16x16x32_bf16 v[180:183], a[28:31], v[32:35], v[180:183]
    ds_read_b64_tr_b16 a[52:53], v49 offset:256
    ds_read_b64_tr_b16 a[54:55], v49 offset:8448
    v_mfma_f32_16x16x32_bf16 v[188:191], a[28:31], v[36:39], v[188:191]
    s_waitcnt lgkmcnt(8)
    v_add_f32 v63, v63, v27
    v_mfma_f32_16x16x32_bf16 v[192:195], a[32:35], v[32:35], v[192:195]
    ds_read_b64_tr_b16 a[56:57], v50 offset:256
    ds_read_b64_tr_b16 a[58:59], v50 offset:8448
    v_mfma_f32_16x16x32_bf16 v[200:203], a[32:35], v[36:39], v[200:203]
    v_exp_f32 v29, v13
    v_add_f32 v62, v62, v20
    v_mfma_f32_16x16x32_bf16 v[196:199], a[36:39], v[32:35], v[196:199]
    ds_read_b64_tr_b16 a[60:61], v51 offset:256
    ds_read_b64_tr_b16 a[62:63], v51 offset:8448
    v_mfma_f32_16x16x32_bf16 v[204:207], a[36:39], v[36:39], v[204:207]
    s_waitcnt lgkmcnt(8)
    v_exp_f32 v22, v6
    v_mfma_f32_16x16x32_bf16 v[208:211], a[40:43], v[32:35], v[208:211]
    s_barrier
    ds_read_b128 a[0:3], v40 offset:0
    v_add_f32 v63, v63, v28
    v_mfma_f32_16x16x32_bf16 v[216:219], a[40:43], v[36:39], v[216:219]
    v_exp_f32 v30, v14
    v_mfma_f32_16x16x32_bf16 v[212:215], a[44:47], v[32:35], v[212:215]
    ds_read_b128 a[4:7], v41 offset:0
    v_add_f32 v62, v62, v21
    v_mfma_f32_16x16x32_bf16 v[220:223], a[44:47], v[36:39], v[220:223]
    s_waitcnt lgkmcnt(6)
    v_exp_f32 v23, v7
    v_mfma_f32_16x16x32_bf16 v[224:227], a[48:51], v[32:35], v[224:227]
    ds_read_b128 a[8:11], v42 offset:0
    v_add_f32 v63, v63, v29
    v_mfma_f32_16x16x32_bf16 v[232:235], a[48:51], v[36:39], v[232:235]
    v_exp_f32 v31, v15
    v_add_f32 v62, v62, v22
    v_mfma_f32_16x16x32_bf16 v[228:231], a[52:55], v[32:35], v[228:231]
    ds_read_b128 a[12:15], v43 offset:0
    v_add_f32 v63, v63, v30
    v_mfma_f32_16x16x32_bf16 v[236:239], a[52:55], v[36:39], v[236:239]
    s_waitcnt lgkmcnt(4)
    v_add_f32 v62, v62, v23
    v_add_f32 v63, v63, v31
    v_mfma_f32_16x16x32_bf16 v[240:243], a[56:59], v[32:35], v[240:243]
    ds_read_b128 a[16:19], v40 offset:256
    v_max_f32 v51, v62, v63
    v_mfma_f32_16x16x32_bf16 v[248:251], a[56:59], v[36:39], v[248:251]
    v_cmp_lt_f32 vcc, s61, v51
    v_mfma_f32_16x16x32_bf16 v[244:247], a[60:63], v[32:35], v[244:247]
    ds_read_b128 a[20:23], v41 offset:256
    v_mfma_f32_16x16x32_bf16 v[252:255], a[60:63], v[36:39], v[252:255]
    s_waitcnt lgkmcnt(4)
    s_cbranch_vccnz L_rare_b
L_rare_ret_b:
    s_sub_u32 s64, s64, 1
    s_cbranch_scc0 L_loop
    v_mfma_f32_16x16x32_bf16 v[0:3], a[0:3], v[64:67], v[52:55]
    ds_read_b128 a[24:27], v42 offset:256
    v_add_f32 v60, v60, v62
    v_mfma_f32_16x16x32_bf16 v[0:3], a[4:7], v[72:75], v[0:3]
    s_waitcnt lgkmcnt(3)
    v_add_f32 v61, v61, v63
    v_cvt_pk_bf16_f32 v32, v16, v17
    v_mfma_f32_16x16x32_bf16 v[0:3], a[8:11], v[80:83], v[0:3]
    ds_read_b128 a[28:31], v43 offset:256
    v_cvt_pk_bf16_f32 v33, v18, v19
    v_mfma_f32_16x16x32_bf16 v[0:3], a[12:15], v[88:91], v[0:3]
    v_cvt_pk_bf16_f32 v34, v20, v21
    v_cvt_pk_bf16_f32 v35, v22, v23
    v_cvt_pk_bf16_f32 v36, v24, v25
    v_mfma_f32_16x16x32_bf16 v[8:11], a[0:3], v[68:71], v[56:59]
    ds_read_b128 a[32:35], v40 offset:8192
    v_cvt_pk_bf16_f32 v37, v26, v27
    v_mfma_f32_16x16x32_bf16 v[8:11], a[4:7], v[76:79], v[8:11]
    v_cvt_pk_bf16_f32 v38, v28, v29
    v_cvt_pk_bf16_f32 v39, v30, v31
    v_mfma_f32_16x16x32_bf16 v[8:11], a[8:11], v[84:87], v[8:11]
    ds_read_b128 a[36:39], v41 offset:8192
    v_mfma_f32_16x16x32_bf16 v[8:11], a[12:15], v[92:95], v[8:11]
    s_waitcnt lgkmcnt(4)
    v_accvgpr_read_b32 v44, a81
    v_add_u32 v44, 32768, v44
    v_xor_b32 v45, 32, v44
    v_mfma_f32_16x16x32_bf16 v[0:3], a[16:19], v[96:99], v[0:3]
    ds_read_b128 a[40:43], v42 offset:8192
    v_xor_b32 v46, 64, v44
    v_mfma_f32_16x16x32_bf16 v[0:3], a[20:23], v[104:107], v[0:3]
    s_waitcnt lgkmcnt(3)
    v_xor_b32 v47, 96, v44
    v_xor_b32 v48, 128, v44
    v_xor_b32 v49, 160, v44
    v_mfma_f32_16x16x32_bf16 v[0:3], a[24:27], v[112:115], v[0:3]
    ds_read_b128 a[44:47], v43 offset:8192
    v_xor_b32 v50, 192, v44
    v_mfma_f32_16x16x32_bf16 v[0:3], a[28:31], v[120:123], v[0:3]
    v_xor_b32 v51, 224, v44
    v_mfma_f32_16x16x32_bf16 v[8:11], a[16:19], v[100:103], v[8:11]
    ds_read_b128 a[48:51], v40 offset:8448
    v_mfma_f32_16x16x32_bf16 v[8:11], a[20:23], v[108:111], v[8:11]
    v_mfma_f32_16x16x32_bf16 v[8:11], a[24:27], v[116:119], v[8:11]
    ds_read_b128 a[52:55], v41 offset:8448
    v_mfma_f32_16x16x32_bf16 v[8:11], a[28:31], v[124:127], v[8:11]
    s_waitcnt lgkmcnt(4)
    v_mfma_f32_16x16x32_bf16 v[4:7], a[32:35], v[64:67], v[52:55]
    ds_read_b128 a[56:59], v42 offset:8448
    v_mfma_f32_16x16x32_bf16 v[4:7], a[36:39], v[72:75], v[4:7]
    s_waitcnt lgkmcnt(3)
    v_mfma_f32_16x16x32_bf16 v[4:7], a[40:43], v[80:83], v[4:7]
    ds_read_b128 a[60:63], v43 offset:8448
    v_mfma_f32_16x16x32_bf16 v[4:7], a[44:47], v[88:91], v[4:7]
    v_exp_f32 v16, v0
    v_exp_f32 v24, v8
    v_mfma_f32_16x16x32_bf16 v[12:15], a[32:35], v[68:71], v[56:59]
    s_barrier
    ds_read_b64_tr_b16 a[0:1], v44 offset:0
    ds_read_b64_tr_b16 a[2:3], v44 offset:8192
    v_mfma_f32_16x16x32_bf16 v[12:15], a[36:39], v[76:79], v[12:15]
    v_exp_f32 v17, v1
    v_mfma_f32_16x16x32_bf16 v[12:15], a[40:43], v[84:87], v[12:15]
    ds_read_b64_tr_b16 a[4:5], v45 offset:0
    ds_read_b64_tr_b16 a[6:7], v45 offset:8192
    v_exp_f32 v25, v9
    v_mfma_f32_16x16x32_bf16 v[12:15], a[44:47], v[92:95], v[12:15]
    s_waitcnt lgkmcnt(6)
    v_exp_f32 v18, v2
    v_mfma_f32_16x16x32_bf16 v[4:7], a[48:51], v[96:99], v[4:7]
    ds_read_b64_tr_b16 a[8:9], v46 offset:0
    ds_read_b64_tr_b16 a[10:11], v46 offset:8192
    v_mfma_f32_16x16x32_bf16 v[4:7], a[52:55], v[104:107], v[4:7]
    s_waitcnt lgkmcnt(6)
    v_exp_f32 v26, v10
    v_add_f32 v62, v16, v17
    v_mfma_f32_16x16x32_bf16 v[4:7], a[56:59], v[112:115], v[4:7]
    ds_read_b64_tr_b16 a[12:13], v47 offset:0
    ds_read_b64_tr_b16 a[14:15], v47 offset:8192
    v_mfma_f32_16x16x32_bf16 v[4:7], a[60:63], v[120:123], v[4:7]
    v_exp_f32 v19, v3
    v_mfma_f32_16x16x32_bf16 v[12:15], a[48:51], v[100:103], v[12:15]
    ds_read_b64_tr_b16 a[16:17], v48 offset:0
    ds_read_b64_tr_b16 a[18:19], v48 offset:8192
    v_add_f32 v63, v24, v25
    v_mfma_f32_16x16x32_bf16 v[12:15], a[52:55], v[108:111], v[12:15]
    v_exp_f32 v27, v11
    v_mfma_f32_16x16x32_bf16 v[12:15], a[56:59], v[116:119], v[12:15]
    ds_read_b64_tr_b16 a[20:21], v49 offset:0
    ds_read_b64_tr_b16 a[22:23], v49 offset:8192
    v_mfma_f32_16x16x32_bf16 v[12:15], a[60:63], v[124:127], v[12:15]
    s_waitcnt lgkmcnt(8)
    v_add_f32 v62, v62, v18
    v_mfma_f32_16x16x32_bf16 v[128:131], a[0:3], v[32:35], v[128:131]
    ds_read_b64_tr_b16 a[24:25], v50 offset:0
    ds_read_b64_tr_b16 a[26:27], v50 offset:8192
    v_mfma_f32_16x16x32_bf16 v[136:139], a[0:3], v[36:39], v[136:139]
    v_mfma_f32_16x16x32_bf16 v[132:135], a[4:7], v[32:35], v[132:135]
    ds_read_b64_tr_b16 a[28:29], v51 offset:0
    ds_read_b64_tr_b16 a[30:31], v51 offset:8192
    v_mfma_f32_16x16x32_bf16 v[140:143], a[4:7], v[36:39], v[140:143]
    s_waitcnt lgkmcnt(8)
    v_exp_f32 v20, v4
    v_add_f32 v63, v63, v26
    v_mfma_f32_16x16x32_bf16 v[144:147], a[8:11], v[32:35], v[144:147]
    ds_read_b64_tr_b16 a[32:33], v44 offset:256
    ds_read_b64_tr_b16 a[34:35], v44 offset:8448
    v_mfma_f32_16x16x32_bf16 v[152:155], a[8:11], v[36:39], v[152:155]
    v_accvgpr_read_b32 v44, a81
    v_add_u32 v44, 49152, v44
    v_mfma_f32_16x16x32_bf16 v[148:151], a[12:15], v[32:35], v[148:151]
    ds_read_b64_tr_b16 a[36:37], v45 offset:256
    ds_read_b64_tr_b16 a[38:39], v45 offset:8448
    v_exp_f32 v28, v12
    v_mfma_f32_16x16x32_bf16 v[156:159], a[12:15], v[36:39], v[156:159]
    s_waitcnt lgkmcnt(8)
    v_xor_b32 v45, 32, v44
    v_add_f32 v62, v62, v19
    v_mfma_f32_16x16x32_bf16 v[160:163], a[16:19], v[32:35], v[160:163]
    ds_read_b64_tr_b16 a[40:41], v46 offset:256
    ds_read_b64_tr_b16 a[42:43], v46 offset:8448
    v_mfma_f32_16x16x32_bf16 v[168:171], a[16:19], v[36:39], v[168:171]
    v_xor_b32 v46, 64, v44
    v_exp_f32 v21, v5
    v_mfma_f32_16x16x32_bf16 v[164:167], a[20:23], v[32:35], v[164:167]
    ds_read_b64_tr_b16 a[44:45], v47 offset:256
    ds_read_b64_tr_b16 a[46:47], v47 offset:8448
    v_mfma_f32_16x16x32_bf16 v[172:175], a[20:23], v[36:39], v[172:175]
    s_waitcnt lgkmcnt(8)
    v_xor_b32 v47, 96, v44
    v_add_f32 v63, v63, v27
    v_mfma_f32_16x16x32_bf16 v[176:179], a[24:27], v[32:35], v[176:179]
    ds_read_b64_tr_b16 a[48:49], v48 offset:256
    ds_read_b64_tr_b16 a[50:51], v48 offset:8448
    v_mfma_f32_16x16x32_bf16 v[184:187], a[24:27], v[36:39], v[184:187]
    v_xor_b32 v48, 128, v44
    v_exp_f32 v29, v13
    v_mfma_f32_16x16x32_bf16 v[180:183], a[28:31], v[32:35], v[180:183]
    ds_read_b64_tr_b16 a[52:53], v49 offset:256
    ds_read_b64_tr_b16 a[54:55], v49 offset:8448
    v_mfma_f32_16x16x32_bf16 v[188:191], a[28:31], v[36:39], v[188:191]
    s_waitcnt lgkmcnt(8)
    v_xor_b32 v49, 160, v44
    v_add_f32 v62, v62, v20
    v_mfma_f32_16x16x32_bf16 v[192:195], a[32:35], v[32:35], v[192:195]
    ds_read_b64_tr_b16 a[56:57], v50 offset:256
    ds_read_b64_tr_b16 a[58:59], v50 offset:8448
    v_mfma_f32_16x16x32_bf16 v[200:203], a[32:35], v[36:39], v[200:203]
    v_exp_f32 v22, v6
    v_add_f32 v63, v63, v28
    v_mfma_f32_16x16x32_bf16 v[196:199], a[36:39], v[32:35], v[196:199]
    ds_read_b64_tr_b16 a[60:61], v51 offset:256
    ds_read_b64_tr_b16 a[62:63], v51 offset:8448
    v_mfma_f32_16x16x32_bf16 v[204:207], a[36:39], v[36:39], v[204:207]
    s_waitcnt lgkmcnt(8)
    v_exp_f32 v30, v14
    v_add_f32 v62, v62, v21
    v_mfma_f32_16x16x32_bf16 v[208:211], a[40:43], v[32:35], v[208:211]
    s_barrier
    ds_read_b64_tr_b16 a[0:1], v44 offset:0
    ds_read_b64_tr_b16 a[2:3], v44 offset:8192
    v_mfma_f32_16x16x32_bf16 v[216:219], a[40:43], v[36:39], v[216:219]
    v_exp_f32 v23, v7
    v_mfma_f32_16x16x32_bf16 v[212:215], a[44:47], v[32:35], v[212:215]
    ds_read_b64_tr_b16 a[4:5], v45 offset:0
    ds_read_b64_tr_b16 a[6:7], v45 offset:8192
    v_add_f32 v63, v63, v29
    v_mfma_f32_16x16x32_bf16 v[220:223], a[44:47], v[36:39], v[220:223]
    s_waitcnt lgkmcnt(8)
    v_exp_f32 v31, v15
    v_mfma_f32_16x16x32_bf16 v[224:227], a[48:51], v[32:35], v[224:227]
    ds_read_b64_tr_b16 a[8:9], v46 offset:0
    ds_read_b64_tr_b16 a[10:11], v46 offset:8192
    v_mfma_f32_16x16x32_bf16 v[232:235], a[48:51], v[36:39], v[232:235]
    v_add_f32 v62, v62, v22
    v_add_f32 v63, v63, v30
    v_add_f32 v62, v62, v23
    v_mfma_f32_16x16x32_bf16 v[228:231], a[52:55], v[32:35], v[228:231]
    ds_read_b64_tr_b16 a[12:13], v47 offset:0
    ds_read_b64_tr_b16 a[14:15], v47 offset:8192
    v_mfma_f32_16x16x32_bf16 v[236:239], a[52:55], v[36:39], v[236:239]
    s_waitcnt lgkmcnt(8)
    v_add_f32 v63, v63, v31
    v_max_f32 v40, v62, v63
    v_mfma_f32_16x16x32_bf16 v[240:243], a[56:59], v[32:35], v[240:243]
    ds_read_b64_tr_b16 a[16:17], v48 offset:0
    ds_read_b64_tr_b16 a[18:19], v48 offset:8192
    v_cmp_lt_f32 vcc, s61, v40
    v_mfma_f32_16x16x32_bf16 v[248:251], a[56:59], v[36:39], v[248:251]
    v_xor_b32 v50, 192, v44
    v_xor_b32 v51, 224, v44
    v_mfma_f32_16x16x32_bf16 v[244:247], a[60:63], v[32:35], v[244:247]
    ds_read_b64_tr_b16 a[20:21], v49 offset:0
    ds_read_b64_tr_b16 a[22:23], v49 offset:8192
    v_mfma_f32_16x16x32_bf16 v[252:255], a[60:63], v[36:39], v[252:255]
    s_waitcnt lgkmcnt(8)
    s_cbranch_vccnz L_rare_c
L_rare_ret_c:
    v_cvt_pk_bf16_f32 v32, v16, v17
    v_cvt_pk_bf16_f32 v33, v18, v19
    v_cvt_pk_bf16_f32 v34, v20, v21
    v_cvt_pk_bf16_f32 v35, v22, v23
    v_cvt_pk_bf16_f32 v36, v24, v25
    v_cvt_pk_bf16_f32 v37, v26, v27
    v_cvt_pk_bf16_f32 v38, v28, v29
    v_cvt_pk_bf16_f32 v39, v30, v31
    v_add_f32 v60, v60, v62
    v_add_f32 v61, v61, v63
    v_mfma_f32_16x16x32_bf16 v[128:131], a[0:3], v[32:35], v[128:131]
    ds_read_b64_tr_b16 a[24:25], v50 offset:0
    ds_read_b64_tr_b16 a[26:27], v50 offset:8192
    v_mfma_f32_16x16x32_bf16 v[136:139], a[0:3], v[36:39], v[136:139]
    v_accvgpr_read_b32 v54, a82
    v_mov_b32 v62, v60
    v_mfma_f32_16x16x32_bf16 v[132:135], a[4:7], v[32:35], v[132:135]
    ds_read_b64_tr_b16 a[28:29], v51 offset:0
    ds_read_b64_tr_b16 a[30:31], v51 offset:8192
    v_mov_b32 v63, v61
    v_mfma_f32_16x16x32_bf16 v[140:143], a[4:7], v[36:39], v[140:143]
    s_waitcnt lgkmcnt(8)
    s_nop 1
    v_permlane32_swap_b32 v60, v62
    v_mfma_f32_16x16x32_bf16 v[144:147], a[8:11], v[32:35], v[144:147]
    ds_read_b64_tr_b16 a[32:33], v44 offset:256
    ds_read_b64_tr_b16 a[34:35], v44 offset:8448
    v_permlane32_swap_b32 v61, v63
    v_mfma_f32_16x16x32_bf16 v[152:155], a[8:11], v[36:39], v[152:155]
    v_add_f32 v60, v60, v62
    v_add_f32 v61, v61, v63
    v_mfma_f32_16x16x32_bf16 v[148:151], a[12:15], v[32:35], v[148:151]
    ds_read_b64_tr_b16 a[36:37], v45 offset:256
    ds_read_b64_tr_b16 a[38:39], v45 offset:8448
    v_mov_b32 v62, v60
    v_mfma_f32_16x16x32_bf16 v[156:159], a[12:15], v[36:39], v[156:159]
    s_waitcnt lgkmcnt(8)
    v_mov_b32 v63, v61
    s_nop 1
    v_mfma_f32_16x16x32_bf16 v[160:163], a[16:19], v[32:35], v[160:163]
    ds_read_b64_tr_b16 a[40:41], v46 offset:256
    ds_read_b64_tr_b16 a[42:43], v46 offset:8448
    v_mfma_f32_16x16x32_bf16 v[168:171], a[16:19], v[36:39], v[168:171]
    v_permlane16_swap_b32 v60, v62
    v_permlane16_swap_b32 v61, v63
    v_add_f32 v60, v60, v62
    v_mfma_f32_16x16x32_bf16 v[164:167], a[20:23], v[32:35], v[164:167]
    ds_read_b64_tr_b16 a[44:45], v47 offset:256
    ds_read_b64_tr_b16 a[46:47], v47 offset:8448
    v_mfma_f32_16x16x32_bf16 v[172:175], a[20:23], v[36:39], v[172:175]
    s_waitcnt lgkmcnt(8)
    v_add_f32 v61, v61, v63
    v_rcp_f32 v60, v60
    v_mfma_f32_16x16x32_bf16 v[176:179], a[24:27], v[32:35], v[176:179]
    ds_read_b64_tr_b16 a[48:49], v48 offset:256
    ds_read_b64_tr_b16 a[50:51], v48 offset:8448
    v_mfma_f32_16x16x32_bf16 v[184:187], a[24:27], v[36:39], v[184:187]
    v_rcp_f32 v61, v61
    v_add_u32 v44, 65536, v54
    v_mfma_f32_16x16x32_bf16 v[180:183], a[28:31], v[32:35], v[180:183]
    ds_read_b64_tr_b16 a[52:53], v49 offset:256
    ds_read_b64_tr_b16 a[54:55], v49 offset:8448
    v_mfma_f32_16x16x32_bf16 v[188:191], a[28:31], v[36:39], v[188:191]
    s_waitcnt lgkmcnt(8)
    v_xor_b32 v45, 32, v44
    v_xor_b32 v46, 64, v44
    v_xor_b32 v47, 96, v44
    v_mbcnt_lo_u32_b32 v55, -1, 0
    v_mbcnt_hi_u32_b32 v55, -1, v55
    v_mul_u32_u24 v52, 256, v55
    v_lshlrev_b32 v55, 4, v55
    v_pk_mul_f32 v[128:129], v[128:129], v[60:61] op_sel:[0,0] op_sel_hi:[1,0]
    v_pk_mul_f32 v[130:131], v[130:131], v[60:61] op_sel:[0,0] op_sel_hi:[1,0]
    v_pk_mul_f32 v[132:133], v[132:133], v[60:61] op_sel:[0,0] op_sel_hi:[1,0]
    v_pk_mul_f32 v[134:135], v[134:135], v[60:61] op_sel:[0,0] op_sel_hi:[1,0]
    v_pk_mul_f32 v[136:137], v[136:137], v[60:61] op_sel:[0,1] op_sel_hi:[1,1]
    v_pk_mul_f32 v[138:139], v[138:139], v[60:61] op_sel:[0,1] op_sel_hi:[1,1]
    v_pk_mul_f32 v[140:141], v[140:141], v[60:61] op_sel:[0,1] op_sel_hi:[1,1]
    v_pk_mul_f32 v[142:143], v[142:143], v[60:61] op_sel:[0,1] op_sel_hi:[1,1]
    v_pk_mul_f32 v[144:145], v[144:145], v[60:61] op_sel:[0,0] op_sel_hi:[1,0]
    v_pk_mul_f32 v[146:147], v[146:147], v[60:61] op_sel:[0,0] op_sel_hi:[1,0]
    v_pk_mul_f32 v[148:149], v[148:149], v[60:61] op_sel:[0,0] op_sel_hi:[1,0]
    v_pk_mul_f32 v[150:151], v[150:151], v[60:61] op_sel:[0,0] op_sel_hi:[1,0]
    v_pk_mul_f32 v[152:153], v[152:153], v[60:61] op_sel:[0,1] op_sel_hi:[1,1]
    v_pk_mul_f32 v[154:155], v[154:155], v[60:61] op_sel:[0,1] op_sel_hi:[1,1]
    v_pk_mul_f32 v[156:157], v[156:157], v[60:61] op_sel:[0,1] op_sel_hi:[1,1]
    v_pk_mul_f32 v[158:159], v[158:159], v[60:61] op_sel:[0,1] op_sel_hi:[1,1]
    v_mfma_f32_16x16x32_bf16 v[192:195], a[32:35], v[32:35], v[192:195]
    ds_read_b64_tr_b16 a[56:57], v50 offset:256
    ds_read_b64_tr_b16 a[58:59], v50 offset:8448
    v_mfma_f32_16x16x32_bf16 v[200:203], a[32:35], v[36:39], v[200:203]
    v_cvt_pk_bf16_f32 v64, v128, v129
    v_cvt_pk_bf16_f32 v65, v130, v131
    v_mfma_f32_16x16x32_bf16 v[196:199], a[36:39], v[32:35], v[196:199]
    ds_read_b64_tr_b16 a[60:61], v51 offset:256
    ds_read_b64_tr_b16 a[62:63], v51 offset:8448
    v_mfma_f32_16x16x32_bf16 v[204:207], a[36:39], v[36:39], v[204:207]
    s_waitcnt lgkmcnt(8)
    v_cvt_pk_bf16_f32 v66, v132, v133
    v_cvt_pk_bf16_f32 v67, v134, v135
    v_mfma_f32_16x16x32_bf16 v[208:211], a[40:43], v[32:35], v[208:211]
    s_barrier
    ds_read_b64_tr_b16 a[0:1], v44 offset:0
    ds_read_b64_tr_b16 a[2:3], v44 offset:2048
    v_mfma_f32_16x16x32_bf16 v[216:219], a[40:43], v[36:39], v[216:219]
    v_cvt_pk_bf16_f32 v68, v136, v137
    v_cvt_pk_bf16_f32 v69, v138, v139
    v_mfma_f32_16x16x32_bf16 v[212:215], a[44:47], v[32:35], v[212:215]
    ds_read_b64_tr_b16 a[4:5], v45 offset:0
    ds_read_b64_tr_b16 a[6:7], v45 offset:2048
    v_mfma_f32_16x16x32_bf16 v[220:223], a[44:47], v[36:39], v[220:223]
    s_waitcnt lgkmcnt(8)
    v_cvt_pk_bf16_f32 v70, v140, v141
    v_cvt_pk_bf16_f32 v71, v142, v143
    v_mfma_f32_16x16x32_bf16 v[224:227], a[48:51], v[32:35], v[224:227]
    ds_read_b64_tr_b16 a[8:9], v46 offset:0
    ds_read_b64_tr_b16 a[10:11], v46 offset:2048
    v_mfma_f32_16x16x32_bf16 v[232:235], a[48:51], v[36:39], v[232:235]
    v_cvt_pk_bf16_f32 v72, v144, v145
    v_cvt_pk_bf16_f32 v73, v146, v147
    v_mfma_f32_16x16x32_bf16 v[228:231], a[52:55], v[32:35], v[228:231]
    ds_read_b64_tr_b16 a[12:13], v47 offset:0
    ds_read_b64_tr_b16 a[14:15], v47 offset:2048
    v_mfma_f32_16x16x32_bf16 v[236:239], a[52:55], v[36:39], v[236:239]
    s_waitcnt lgkmcnt(8)
    v_cvt_pk_bf16_f32 v74, v148, v149
    v_cvt_pk_bf16_f32 v75, v150, v151
    v_pk_mul_f32 v[160:161], v[160:161], v[60:61] op_sel:[0,0] op_sel_hi:[1,0]
    v_pk_mul_f32 v[162:163], v[162:163], v[60:61] op_sel:[0,0] op_sel_hi:[1,0]
    v_pk_mul_f32 v[164:165], v[164:165], v[60:61] op_sel:[0,0] op_sel_hi:[1,0]
    v_pk_mul_f32 v[166:167], v[166:167], v[60:61] op_sel:[0,0] op_sel_hi:[1,0]
    v_pk_mul_f32 v[168:169], v[168:169], v[60:61] op_sel:[0,1] op_sel_hi:[1,1]
    v_pk_mul_f32 v[170:171], v[170:171], v[60:61] op_sel:[0,1] op_sel_hi:[1,1]
    v_pk_mul_f32 v[172:173], v[172:173], v[60:61] op_sel:[0,1] op_sel_hi:[1,1]
    v_pk_mul_f32 v[174:175], v[174:175], v[60:61] op_sel:[0,1] op_sel_hi:[1,1]
    v_pk_mul_f32 v[176:177], v[176:177], v[60:61] op_sel:[0,0] op_sel_hi:[1,0]
    v_pk_mul_f32 v[178:179], v[178:179], v[60:61] op_sel:[0,0] op_sel_hi:[1,0]
    v_pk_mul_f32 v[180:181], v[180:181], v[60:61] op_sel:[0,0] op_sel_hi:[1,0]
    v_pk_mul_f32 v[182:183], v[182:183], v[60:61] op_sel:[0,0] op_sel_hi:[1,0]
    v_pk_mul_f32 v[184:185], v[184:185], v[60:61] op_sel:[0,1] op_sel_hi:[1,1]
    v_pk_mul_f32 v[186:187], v[186:187], v[60:61] op_sel:[0,1] op_sel_hi:[1,1]
    v_pk_mul_f32 v[188:189], v[188:189], v[60:61] op_sel:[0,1] op_sel_hi:[1,1]
    v_pk_mul_f32 v[190:191], v[190:191], v[60:61] op_sel:[0,1] op_sel_hi:[1,1]
    v_mfma_f32_16x16x32_bf16 v[240:243], a[56:59], v[32:35], v[240:243]
    ds_read_b64_tr_b16 a[16:17], v44 offset:4096
    ds_read_b64_tr_b16 a[18:19], v44 offset:6144
    v_mfma_f32_16x16x32_bf16 v[248:251], a[56:59], v[36:39], v[248:251]
    v_cvt_pk_bf16_f32 v76, v152, v153
    v_cvt_pk_bf16_f32 v77, v154, v155
    v_mfma_f32_16x16x32_bf16 v[244:247], a[60:63], v[32:35], v[244:247]
    ds_read_b64_tr_b16 a[20:21], v45 offset:4096
    ds_read_b64_tr_b16 a[22:23], v45 offset:6144
    v_mfma_f32_16x16x32_bf16 v[252:255], a[60:63], v[36:39], v[252:255]
    s_waitcnt lgkmcnt(8)
    v_cvt_pk_bf16_f32 v78, v156, v157
    v_cvt_pk_bf16_f32 v79, v158, v159
    v_mfma_f32_16x16x32_bf16 v[128:131], a[0:3], v[64:67], 0
    ds_read_b64_tr_b16 a[24:25], v46 offset:4096
    ds_read_b64_tr_b16 a[26:27], v46 offset:6144
    v_mfma_f32_16x16x32_bf16 v[136:139], a[0:3], v[68:71], 0
    v_cvt_pk_bf16_f32 v80, v160, v161
    v_cvt_pk_bf16_f32 v81, v162, v163
    v_mfma_f32_16x16x32_bf16 v[132:135], a[4:7], v[64:67], 0
    ds_read_b64_tr_b16 a[28:29], v47 offset:4096
    ds_read_b64_tr_b16 a[30:31], v47 offset:6144
    v_mfma_f32_16x16x32_bf16 v[140:143], a[4:7], v[68:71], 0
    s_waitcnt lgkmcnt(8)
    v_cvt_pk_bf16_f32 v82, v164, v165
    v_cvt_pk_bf16_f32 v83, v166, v167
    v_mfma_f32_16x16x32_bf16 v[144:147], a[8:11], v[64:67], 0
    ds_read_b64_tr_b16 a[32:33], v44 offset:8192
    ds_read_b64_tr_b16 a[34:35], v44 offset:10240
    v_mfma_f32_16x16x32_bf16 v[152:155], a[8:11], v[68:71], 0
    v_cvt_pk_bf16_f32 v84, v168, v169
    v_cvt_pk_bf16_f32 v85, v170, v171
    v_mfma_f32_16x16x32_bf16 v[148:151], a[12:15], v[64:67], 0
    ds_read_b64_tr_b16 a[36:37], v45 offset:8192
    ds_read_b64_tr_b16 a[38:39], v45 offset:10240
    v_mfma_f32_16x16x32_bf16 v[156:159], a[12:15], v[68:71], 0
    s_waitcnt lgkmcnt(8)
    v_cvt_pk_bf16_f32 v86, v172, v173
    v_cvt_pk_bf16_f32 v87, v174, v175
    v_mfma_f32_16x16x32_bf16 v[128:131], a[16:19], v[72:75], v[128:131]
    ds_read_b64_tr_b16 a[40:41], v46 offset:8192
    ds_read_b64_tr_b16 a[42:43], v46 offset:10240
    v_mfma_f32_16x16x32_bf16 v[136:139], a[16:19], v[76:79], v[136:139]
    v_cvt_pk_bf16_f32 v88, v176, v177
    v_cvt_pk_bf16_f32 v89, v178, v179
    v_mfma_f32_16x16x32_bf16 v[132:135], a[20:23], v[72:75], v[132:135]
    ds_read_b64_tr_b16 a[44:45], v47 offset:8192
    ds_read_b64_tr_b16 a[46:47], v47 offset:10240
    v_mfma_f32_16x16x32_bf16 v[140:143], a[20:23], v[76:79], v[140:143]
    s_waitcnt lgkmcnt(8)
    v_cvt_pk_bf16_f32 v90, v180, v181
    v_cvt_pk_bf16_f32 v91, v182, v183
    v_pk_mul_f32 v[192:193], v[192:193], v[60:61] op_sel:[0,0] op_sel_hi:[1,0]
    v_pk_mul_f32 v[194:195], v[194:195], v[60:61] op_sel:[0,0] op_sel_hi:[1,0]
    v_pk_mul_f32 v[196:197], v[196:197], v[60:61] op_sel:[0,0] op_sel_hi:[1,0]
    v_pk_mul_f32 v[198:199], v[198:199], v[60:61] op_sel:[0,0] op_sel_hi:[1,0]
    v_pk_mul_f32 v[200:201], v[200:201], v[60:61] op_sel:[0,1] op_sel_hi:[1,1]
L_pg5:
    s_cbranch_execz L_w2_1
    v_pk_mul_f32 v[202:203], v[202:203], v[60:61] op_sel:[0,1] op_sel_hi:[1,1]
    v_pk_mul_f32 v[204:205], v[204:205], v[60:61] op_sel:[0,1] op_sel_hi:[1,1]
    v_pk_mul_f32 v[206:207], v[206:207], v[60:61] op_sel:[0,1] op_sel_hi:[1,1]
    v_pk_mul_f32 v[208:209], v[208:209], v[60:61] op_sel:[0,0] op_sel_hi:[1,0]
    v_pk_mul_f32 v[210:211], v[210:211], v[60:61] op_sel:[0,0] op_sel_hi:[1,0]
    v_pk_mul_f32 v[212:213], v[212:213], v[60:61] op_sel:[0,0] op_sel_hi:[1,0]
    v_pk_mul_f32 v[214:215], v[214:215], v[60:61] op_sel:[0,0] op_sel_hi:[1,0]
    v_pk_mul_f32 v[216:217], v[216:217], v[60:61] op_sel:[0,1] op_sel_hi:[1,1]
    v_pk_mul_f32 v[218:219], v[218:219], v[60:61] op_sel:[0,1] op_sel_hi:[1,1]
    v_pk_mul_f32 v[220:221], v[220:221], v[60:61] op_sel:[0,1] op_sel_hi:[1,1]
    v_pk_mul_f32 v[222:223], v[222:223], v[60:61] op_sel:[0,1] op_sel_hi:[1,1]
    v_mfma_f32_16x16x32_bf16 v[144:147], a[24:27], v[72:75], v[144:147]
    ds_read_b64_tr_b16 a[48:49], v44 offset:12288
    ds_read_b64_tr_b16 a[50:51], v44 offset:14336
    v_mfma_f32_16x16x32_bf16 v[152:155], a[24:27], v[76:79], v[152:155]
    v_add_u32 v44, 81920, v54
    v_cvt_pk_bf16_f32 v92, v184, v185
    v_mfma_f32_16x16x32_bf16 v[148:151], a[28:31], v[72:75], v[148:151]
    ds_read_b64_tr_b16 a[52:53], v45 offset:12288
    ds_read_b64_tr_b16 a[54:55], v45 offset:14336
    v_mfma_f32_16x16x32_bf16 v[156:159], a[28:31], v[76:79], v[156:159]
    s_waitcnt lgkmcnt(8)
    v_xor_b32 v45, 32, v44
    v_cvt_pk_bf16_f32 v93, v186, v187
    v_mfma_f32_16x16x32_bf16 v[128:131], a[32:35], v[80:83], v[128:131]
    ds_read_b64_tr_b16 a[56:57], v46 offset:12288
    ds_read_b64_tr_b16 a[58:59], v46 offset:14336
    v_mfma_f32_16x16x32_bf16 v[136:139], a[32:35], v[84:87], v[136:139]
    v_cvt_pk_bf16_f32 v94, v188, v189
    v_cvt_pk_bf16_f32 v95, v190, v191
    v_mfma_f32_16x16x32_bf16 v[132:135], a[36:39], v[80:83], v[132:135]
    ds_read_b64_tr_b16 a[60:61], v47 offset:12288
    ds_read_b64_tr_b16 a[62:63], v47 offset:14336
    v_mfma_f32_16x16x32_bf16 v[140:143], a[36:39], v[84:87], v[140:143]
    s_waitcnt lgkmcnt(8)
    v_xor_b32 v46, 64, v44
    v_xor_b32 v47, 96, v44
    v_mfma_f32_16x16x32_bf16 v[144:147], a[40:43], v[80:83], v[144:147]
    s_barrier
    ds_read_b64_tr_b16 a[0:1], v44 offset:0
    ds_read_b64_tr_b16 a[2:3], v44 offset:2048
    v_mfma_f32_16x16x32_bf16 v[152:155], a[40:43], v[84:87], v[152:155]
    v_cvt_pk_bf16_f32 v96, v192, v193
    v_cvt_pk_bf16_f32 v97, v194, v195
    v_mfma_f32_16x16x32_bf16 v[148:151], a[44:47], v[80:83], v[148:151]
    ds_read_b64_tr_b16 a[4:5], v45 offset:0
    ds_read_b64_tr_b16 a[6:7], v45 offset:2048
    v_mfma_f32_16x16x32_bf16 v[156:159], a[44:47], v[84:87], v[156:159]
    s_waitcnt lgkmcnt(8)
    v_cvt_pk_bf16_f32 v98, v196, v197
    v_cvt_pk_bf16_f32 v99, v198, v199
    v_mfma_f32_16x16x32_bf16 v[128:131], a[48:51], v[88:91], v[128:131]
    ds_read_b64_tr_b16 a[8:9], v46 offset:0
    ds_read_b64_tr_b16 a[10:11], v46 offset:2048
    v_mfma_f32_16x16x32_bf16 v[136:139], a[48:51], v[92:95], v[136:139]
    v_cvt_pk_bf16_f32 v100, v200, v201
    v_cvt_pk_bf16_f32 v101, v202, v203
    v_mfma_f32_16x16x32_bf16 v[132:135], a[52:55], v[88:91], v[132:135]
    ds_read_b64_tr_b16 a[12:13], v47 offset:0
    ds_read_b64_tr_b16 a[14:15], v47 offset:2048
    v_mfma_f32_16x16x32_bf16 v[140:143], a[52:55], v[92:95], v[140:143]
    s_waitcnt lgkmcnt(8)
    v_cvt_pk_bf16_f32 v102, v204, v205
    v_cvt_pk_bf16_f32 v103, v206, v207
    v_pk_mul_f32 v[224:225], v[224:225], v[60:61] op_sel:[0,0] op_sel_hi:[1,0]
    v_pk_mul_f32 v[226:227], v[226:227], v[60:61] op_sel:[0,0] op_sel_hi:[1,0]
    v_pk_mul_f32 v[228:229], v[228:229], v[60:61] op_sel:[0,0] op_sel_hi:[1,0]
    v_pk_mul_f32 v[230:231], v[230:231], v[60:61] op_sel:[0,0] op_sel_hi:[1,0]
    v_pk_mul_f32 v[232:233], v[232:233], v[60:61] op_sel:[0,1] op_sel_hi:[1,1]
    v_pk_mul_f32 v[234:235], v[234:235], v[60:61] op_sel:[0,1] op_sel_hi:[1,1]
    v_pk_mul_f32 v[236:237], v[236:237], v[60:61] op_sel:[0,1] op_sel_hi:[1,1]
    v_pk_mul_f32 v[238:239], v[238:239], v[60:61] op_sel:[0,1] op_sel_hi:[1,1]
    v_pk_mul_f32 v[240:241], v[240:241], v[60:61] op_sel:[0,0] op_sel_hi:[1,0]
    v_pk_mul_f32 v[242:243], v[242:243], v[60:61] op_sel:[0,0] op_sel_hi:[1,0]
    v_pk_mul_f32 v[244:245], v[244:245], v[60:61] op_sel:[0,0] op_sel_hi:[1,0]
    v_pk_mul_f32 v[246:247], v[246:247], v[60:61] op_sel:[0,0] op_sel_hi:[1,0]
    v_pk_mul_f32 v[248:249], v[248:249], v[60:61] op_sel:[0,1] op_sel_hi:[1,1]
    v_pk_mul_f32 v[250:251], v[250:251], v[60:61] op_sel:[0,1] op_sel_hi:[1,1]
    v_pk_mul_f32 v[252:253], v[252:253], v[60:61] op_sel:[0,1] op_sel_hi:[1,1]
    v_pk_mul_f32 v[254:255], v[254:255], v[60:61] op_sel:[0,1] op_sel_hi:[1,1]
    v_mfma_f32_16x16x32_bf16 v[144:147], a[56:59], v[88:91], v[144:147]
    ds_read_b64_tr_b16 a[16:17], v44 offset:4096
    ds_read_b64_tr_b16 a[18:19], v44 offset:6144
    v_mfma_f32_16x16x32_bf16 v[152:155], a[56:59], v[92:95], v[152:155]
    v_cvt_pk_bf16_f32 v104, v208, v209
    v_cvt_pk_bf16_f32 v105, v210, v211
    v_mfma_f32_16x16x32_bf16 v[148:151], a[60:63], v[88:91], v[148:151]
    ds_read_b64_tr_b16 a[20:21], v45 offset:4096
    ds_read_b64_tr_b16 a[22:23], v45 offset:6144
    v_mfma_f32_16x16x32_bf16 v[156:159], a[60:63], v[92:95], v[156:159]
    s_waitcnt lgkmcnt(8)
    v_cvt_pk_bf16_f32 v106, v212, v213
    v_cvt_pk_bf16_f32 v107, v214, v215
    v_mfma_f32_16x16x32_bf16 v[128:131], a[0:3], v[96:99], v[128:131]
    ds_read_b64_tr_b16 a[24:25], v46 offset:4096
    ds_read_b64_tr_b16 a[26:27], v46 offset:6144
    v_mfma_f32_16x16x32_bf16 v[136:139], a[0:3], v[100:103], v[136:139]
    v_cvt_pk_bf16_f32 v108, v216, v217
    v_cvt_pk_bf16_f32 v109, v218, v219
    v_mfma_f32_16x16x32_bf16 v[132:135], a[4:7], v[96:99], v[132:135]
    ds_read_b64_tr_b16 a[28:29], v47 offset:4096
    ds_read_b64_tr_b16 a[30:31], v47 offset:6144
    v_mfma_f32_16x16x32_bf16 v[140:143], a[4:7], v[100:103], v[140:143]
    s_waitcnt lgkmcnt(8)
    v_cvt_pk_bf16_f32 v110, v220, v221
    v_cvt_pk_bf16_f32 v111, v222, v223
    v_mfma_f32_16x16x32_bf16 v[144:147], a[8:11], v[96:99], v[144:147]
    ds_read_b64_tr_b16 a[32:33], v44 offset:8192
    ds_read_b64_tr_b16 a[34:35], v44 offset:10240
    v_mfma_f32_16x16x32_bf16 v[152:155], a[8:11], v[100:103], v[152:155]
    v_cvt_pk_bf16_f32 v112, v224, v225
    v_cvt_pk_bf16_f32 v113, v226, v227
    v_mfma_f32_16x16x32_bf16 v[148:151], a[12:15], v[96:99], v[148:151]
    ds_read_b64_tr_b16 a[36:37], v45 offset:8192
    ds_read_b64_tr_b16 a[38:39], v45 offset:10240
    v_mfma_f32_16x16x32_bf16 v[156:159], a[12:15], v[100:103], v[156:159]
    s_waitcnt lgkmcnt(8)
    v_cvt_pk_bf16_f32 v114, v228, v229
    v_cvt_pk_bf16_f32 v115, v230, v231
    v_mfma_f32_16x16x32_bf16 v[128:131], a[16:19], v[104:107], v[128:131]
    ds_read_b64_tr_b16 a[40:41], v46 offset:8192
    ds_read_b64_tr_b16 a[42:43], v46 offset:10240
    v_mfma_f32_16x16x32_bf16 v[136:139], a[16:19], v[108:111], v[136:139]
    v_cvt_pk_bf16_f32 v116, v232, v233
    v_cvt_pk_bf16_f32 v117, v234, v235
    v_mfma_f32_16x16x32_bf16 v[132:135], a[20:23], v[104:107], v[132:135]
    ds_read_b64_tr_b16 a[44:45], v47 offset:8192
    ds_read_b64_tr_b16 a[46:47], v47 offset:10240
    v_mfma_f32_16x16x32_bf16 v[140:143], a[20:23], v[108:111], v[140:143]
    s_waitcnt lgkmcnt(8)
    v_cvt_pk_bf16_f32 v118, v236, v237
    v_cvt_pk_bf16_f32 v119, v238, v239
    v_mfma_f32_16x16x32_bf16 v[144:147], a[24:27], v[104:107], v[144:147]
    ds_read_b64_tr_b16 a[48:49], v44 offset:12288
    ds_read_b64_tr_b16 a[50:51], v44 offset:14336
    v_mfma_f32_16x16x32_bf16 v[152:155], a[24:27], v[108:111], v[152:155]
    v_add_u32 v44, 98304, v54
    v_cvt_pk_bf16_f32 v120, v240, v241
    v_mfma_f32_16x16x32_bf16 v[148:151], a[28:31], v[104:107], v[148:151]
    ds_read_b64_tr_b16 a[52:53], v45 offset:12288
    ds_read_b64_tr_b16 a[54:55], v45 offset:14336
    v_mfma_f32_16x16x32_bf16 v[156:159], a[28:31], v[108:111], v[156:159]
    s_waitcnt lgkmcnt(8)
    v_cvt_pk_bf16_f32 v121, v242, v243
    v_cvt_pk_bf16_f32 v122, v244, v245
    v_mfma_f32_16x16x32_bf16 v[128:131], a[32:35], v[112:115], v[128:131]
    ds_read_b64_tr_b16 a[56:57], v46 offset:12288
    ds_read_b64_tr_b16 a[58:59], v46 offset:14336
    v_mfma_f32_16x16x32_bf16 v[136:139], a[32:35], v[116:119], v[136:139]
    v_cvt_pk_bf16_f32 v123, v246, v247
    v_cvt_pk_bf16_f32 v124, v248, v249
    v_mfma_f32_16x16x32_bf16 v[132:135], a[36:39], v[112:115], v[132:135]
    ds_read_b64_tr_b16 a[60:61], v47 offset:12288
    ds_read_b64_tr_b16 a[62:63], v47 offset:14336
    v_mfma_f32_16x16x32_bf16 v[140:143], a[36:39], v[116:119], v[140:143]
    s_waitcnt lgkmcnt(8)
    v_cvt_pk_bf16_f32 v125, v250, v251
    v_cvt_pk_bf16_f32 v126, v252, v253
    v_mfma_f32_16x16x32_bf16 v[144:147], a[40:43], v[112:115], v[144:147]
    s_barrier
    ds_read_b64_tr_b16 a[0:1], v44 offset:0
    ds_read_b64_tr_b16 a[2:3], v44 offset:2048
    v_mfma_f32_16x16x32_bf16 v[152:155], a[40:43], v[116:119], v[152:155]
    v_cvt_pk_bf16_f32 v127, v254, v255
    v_xor_b32 v45, 32, v44
    v_mfma_f32_16x16x32_bf16 v[148:151], a[44:47], v[112:115], v[148:151]
    ds_read_b64_tr_b16 a[4:5], v44 offset:4096
    ds_read_b64_tr_b16 a[6:7], v44 offset:6144
    v_mfma_f32_16x16x32_bf16 v[156:159], a[44:47], v[116:119], v[156:159]
    s_waitcnt lgkmcnt(8)
    v_xor_b32 v46, 64, v44
    v_xor_b32 v47, 96, v44
    v_mfma_f32_16x16x32_bf16 v[128:131], a[48:51], v[120:123], v[128:131]
    ds_read_b64_tr_b16 a[8:9], v44 offset:8192
    ds_read_b64_tr_b16 a[10:11], v44 offset:10240
    v_mfma_f32_16x16x32_bf16 v[136:139], a[48:51], v[124:127], v[136:139]
    v_mfma_f32_16x16x32_bf16 v[132:135], a[52:55], v[120:123], v[132:135]
    ds_read_b64_tr_b16 a[12:13], v44 offset:12288
    ds_read_b64_tr_b16 a[14:15], v44 offset:14336
    v_mfma_f32_16x16x32_bf16 v[140:143], a[52:55], v[124:127], v[140:143]
    s_waitcnt lgkmcnt(8)
    v_mfma_f32_16x16x32_bf16 v[144:147], a[56:59], v[120:123], v[144:147]
    ds_read_b64_tr_b16 a[16:17], v45 offset:0
    ds_read_b64_tr_b16 a[18:19], v45 offset:2048
    v_mfma_f32_16x16x32_bf16 v[152:155], a[56:59], v[124:127], v[152:155]
    v_mfma_f32_16x16x32_bf16 v[148:151], a[60:63], v[120:123], v[148:151]
    ds_read_b64_tr_b16 a[20:21], v45 offset:4096
    ds_read_b64_tr_b16 a[22:23], v45 offset:6144
    v_mfma_f32_16x16x32_bf16 v[156:159], a[60:63], v[124:127], v[156:159]
    s_waitcnt lgkmcnt(8)
    v_mfma_f32_16x16x32_bf16 v[160:163], a[0:3], v[64:67], 0
    ds_read_b64_tr_b16 a[24:25], v45 offset:8192
    ds_read_b64_tr_b16 a[26:27], v45 offset:10240
    v_mfma_f32_16x16x32_bf16 v[160:163], a[4:7], v[72:75], v[160:163]
    s_waitcnt lgkmcnt(6)
    v_add_u32 v44, 114688, v54
    v_mfma_f32_16x16x32_bf16 v[160:163], a[8:11], v[80:83], v[160:163]
    ds_read_b64_tr_b16 a[28:29], v45 offset:12288
    ds_read_b64_tr_b16 a[30:31], v45 offset:14336
    v_mfma_f32_16x16x32_bf16 v[160:163], a[12:15], v[88:91], v[160:163]
    v_xor_b32 v45, 32, v44
    v_cvt_pk_bf16_f32 v192, v128, v129
    v_mfma_f32_16x16x32_bf16 v[168:171], a[0:3], v[68:71], 0
    ds_read_b64_tr_b16 a[32:33], v46 offset:0
    ds_read_b64_tr_b16 a[34:35], v46 offset:2048
    v_mfma_f32_16x16x32_bf16 v[168:171], a[4:7], v[76:79], v[168:171]
    v_cvt_pk_bf16_f32 v193, v130, v131
    v_cvt_pk_bf16_f32 v194, v132, v133
    v_mfma_f32_16x16x32_bf16 v[168:171], a[8:11], v[84:87], v[168:171]
    ds_read_b64_tr_b16 a[36:37], v46 offset:4096
    ds_read_b64_tr_b16 a[38:39], v46 offset:6144
    v_mfma_f32_16x16x32_bf16 v[168:171], a[12:15], v[92:95], v[168:171]
    s_waitcnt lgkmcnt(8)
    v_cvt_pk_bf16_f32 v195, v134, v135
    v_cvt_pk_bf16_f32 v196, v136, v137
    v_mfma_f32_16x16x32_bf16 v[164:167], a[16:19], v[64:67], 0
    ds_read_b64_tr_b16 a[40:41], v46 offset:8192
    ds_read_b64_tr_b16 a[42:43], v46 offset:10240
    v_mfma_f32_16x16x32_bf16 v[164:167], a[20:23], v[72:75], v[164:167]
    s_waitcnt lgkmcnt(6)
    v_cvt_pk_bf16_f32 v197, v138, v139
    v_cvt_pk_bf16_f32 v198, v140, v141
    v_mfma_f32_16x16x32_bf16 v[164:167], a[24:27], v[80:83], v[164:167]
    ds_read_b64_tr_b16 a[44:45], v46 offset:12288
    ds_read_b64_tr_b16 a[46:47], v46 offset:14336
    v_mfma_f32_16x16x32_bf16 v[164:167], a[28:31], v[88:91], v[164:167]
    v_xor_b32 v46, 64, v44
    v_cvt_pk_bf16_f32 v199, v142, v143
    v_mfma_f32_16x16x32_bf16 v[172:175], a[16:19], v[68:71], 0
    ds_read_b64_tr_b16 a[48:49], v47 offset:0
    ds_read_b64_tr_b16 a[50:51], v47 offset:2048
    v_mfma_f32_16x16x32_bf16 v[172:175], a[20:23], v[76:79], v[172:175]
    v_cvt_pk_bf16_f32 v200, v144, v145
    v_cvt_pk_bf16_f32 v201, v146, v147
    v_mfma_f32_16x16x32_bf16 v[172:175], a[24:27], v[84:87], v[172:175]
    ds_read_b64_tr_b16 a[52:53], v47 offset:4096
    ds_read_b64_tr_b16 a[54:55], v47 offset:6144
    v_mfma_f32_16x16x32_bf16 v[172:175], a[28:31], v[92:95], v[172:175]
    s_waitcnt lgkmcnt(8)
    v_cvt_pk_bf16_f32 v202, v148, v149
    v_cvt_pk_bf16_f32 v203, v150, v151
    v_mfma_f32_16x16x32_bf16 v[176:179], a[32:35], v[64:67], 0
    ds_read_b64_tr_b16 a[56:57], v47 offset:8192
    ds_read_b64_tr_b16 a[58:59], v47 offset:10240
    v_mfma_f32_16x16x32_bf16 v[176:179], a[36:39], v[72:75], v[176:179]
    s_waitcnt lgkmcnt(6)
    v_cvt_pk_bf16_f32 v204, v152, v153
    v_cvt_pk_bf16_f32 v205, v154, v155
    v_mfma_f32_16x16x32_bf16 v[176:179], a[40:43], v[80:83], v[176:179]
    ds_read_b64_tr_b16 a[60:61], v47 offset:12288
    ds_read_b64_tr_b16 a[62:63], v47 offset:14336
    v_mfma_f32_16x16x32_bf16 v[176:179], a[44:47], v[88:91], v[176:179]
    v_xor_b32 v47, 96, v44
    v_cvt_pk_bf16_f32 v206, v156, v157
    v_mfma_f32_16x16x32_bf16 v[184:187], a[32:35], v[68:71], 0
    ds_read_b64_tr_b16 a[0:1], v44 offset:0
    ds_read_b64_tr_b16 a[2:3], v44 offset:2048
    v_mfma_f32_16x16x32_bf16 v[184:187], a[36:39], v[76:79], v[184:187]
    v_cvt_pk_bf16_f32 v207, v158, v159
    v_mfma_f32_16x16x32_bf16 v[184:187], a[40:43], v[84:87], v[184:187]
    ds_read_b64_tr_b16 a[4:5], v44 offset:4096
    ds_read_b64_tr_b16 a[6:7], v44 offset:6144
    v_mfma_f32_16x16x32_bf16 v[184:187], a[44:47], v[92:95], v[184:187]
    s_waitcnt lgkmcnt(8)
    v_mfma_f32_16x16x32_bf16 v[180:183], a[48:51], v[64:67], 0
    ds_read_b64_tr_b16 a[8:9], v44 offset:8192
    ds_read_b64_tr_b16 a[10:11], v44 offset:10240
    v_mfma_f32_16x16x32_bf16 v[180:183], a[52:55], v[72:75], v[180:183]
    s_waitcnt lgkmcnt(6)
    v_mfma_f32_16x16x32_bf16 v[180:183], a[56:59], v[80:83], v[180:183]
    ds_read_b64_tr_b16 a[12:13], v44 offset:12288
    ds_read_b64_tr_b16 a[14:15], v44 offset:14336
    v_mfma_f32_16x16x32_bf16 v[180:183], a[60:63], v[88:91], v[180:183]
    v_mfma_f32_16x16x32_bf16 v[188:191], a[48:51], v[68:71], 0
    ds_read_b64_tr_b16 a[16:17], v45 offset:0
    ds_read_b64_tr_b16 a[18:19], v45 offset:2048
    v_mfma_f32_16x16x32_bf16 v[188:191], a[52:55], v[76:79], v[188:191]
    v_mfma_f32_16x16x32_bf16 v[188:191], a[56:59], v[84:87], v[188:191]
    ds_read_b64_tr_b16 a[20:21], v45 offset:4096
    ds_read_b64_tr_b16 a[22:23], v45 offset:6144
    v_mfma_f32_16x16x32_bf16 v[188:191], a[60:63], v[92:95], v[188:191]
    s_waitcnt lgkmcnt(8)
    v_mfma_f32_16x16x32_bf16 v[160:163], a[0:3], v[96:99], v[160:163]
    ds_read_b64_tr_b16 a[24:25], v45 offset:8192
    ds_read_b64_tr_b16 a[26:27], v45 offset:10240
    v_mfma_f32_16x16x32_bf16 v[160:163], a[4:7], v[104:107], v[160:163]
    s_waitcnt lgkmcnt(6)
    v_add_u32 v44, 131072, v54
    v_mfma_f32_16x16x32_bf16 v[160:163], a[8:11], v[112:115], v[160:163]
    ds_read_b64_tr_b16 a[28:29], v45 offset:12288
    ds_read_b64_tr_b16 a[30:31], v45 offset:14336
    v_mfma_f32_16x16x32_bf16 v[160:163], a[12:15], v[120:123], v[160:163]
    v_xor_b32 v45, 32, v44
    v_mfma_f32_16x16x32_bf16 v[168:171], a[0:3], v[100:103], v[168:171]
    ds_read_b64_tr_b16 a[32:33], v46 offset:0
    ds_read_b64_tr_b16 a[34:35], v46 offset:2048
    v_mfma_f32_16x16x32_bf16 v[168:171], a[4:7], v[108:111], v[168:171]
    v_mfma_f32_16x16x32_bf16 v[168:171], a[8:11], v[116:119], v[168:171]
    ds_read_b64_tr_b16 a[36:37], v46 offset:4096
    ds_read_b64_tr_b16 a[38:39], v46 offset:6144
    v_mfma_f32_16x16x32_bf16 v[168:171], a[12:15], v[124:127], v[168:171]
    s_waitcnt lgkmcnt(8)
    v_mfma_f32_16x16x32_bf16 v[164:167], a[16:19], v[96:99], v[164:167]
    ds_read_b64_tr_b16 a[40:41], v46 offset:8192
    ds_read_b64_tr_b16 a[42:43], v46 offset:10240
    v_mfma_f32_16x16x32_bf16 v[164:167], a[20:23], v[104:107], v[164:167]
    s_waitcnt lgkmcnt(6)
    v_mfma_f32_16x16x32_bf16 v[164:167], a[24:27], v[112:115], v[164:167]
    ds_read_b64_tr_b16 a[44:45], v46 offset:12288
    ds_read_b64_tr_b16 a[46:47], v46 offset:14336
    v_mfma_f32_16x16x32_bf16 v[164:167], a[28:31], v[120:123], v[164:167]
    v_xor_b32 v46, 64, v44
    v_mfma_f32_16x16x32_bf16 v[172:175], a[16:19], v[100:103], v[172:175]
    ds_read_b64_tr_b16 a[48:49], v47 offset:0
    ds_read_b64_tr_b16 a[50:51], v47 offset:2048
    v_mfma_f32_16x16x32_bf16 v[172:175], a[20:23], v[108:111], v[172:175]
    v_mfma_f32_16x16x32_bf16 v[172:175], a[24:27], v[116:119], v[172:175]
    ds_read_b64_tr_b16 a[52:53], v47 offset:4096
    ds_read_b64_tr_b16 a[54:55], v47 offset:6144
    v_mfma_f32_16x16x32_bf16 v[172:175], a[28:31], v[124:127], v[172:175]
    s_waitcnt lgkmcnt(8)
    v_mfma_f32_16x16x32_bf16 v[176:179], a[32:35], v[96:99], v[176:179]
    ds_read_b64_tr_b16 a[56:57], v47 offset:8192
    ds_read_b64_tr_b16 a[58:59], v47 offset:10240
    v_mfma_f32_16x16x32_bf16 v[176:179], a[36:39], v[104:107], v[176:179]
    s_waitcnt lgkmcnt(6)
    v_mfma_f32_16x16x32_bf16 v[176:179], a[40:43], v[112:115], v[176:179]
    ds_read_b64_tr_b16 a[60:61], v47 offset:12288
    ds_read_b64_tr_b16 a[62:63], v47 offset:14336
    v_mfma_f32_16x16x32_bf16 v[176:179], a[44:47], v[120:123], v[176:179]
    v_xor_b32 v47, 96, v44
    v_mfma_f32_16x16x32_bf16 v[184:187], a[32:35], v[100:103], v[184:187]
    s_barrier
    ds_read_b64_tr_b16 a[0:1], v44 offset:0
    ds_read_b64_tr_b16 a[2:3], v44 offset:2048
    v_mfma_f32_16x16x32_bf16 v[184:187], a[36:39], v[108:111], v[184:187]
    v_mfma_f32_16x16x32_bf16 v[184:187], a[40:43], v[116:119], v[184:187]
    ds_read_b64_tr_b16 a[4:5], v44 offset:4096
    ds_read_b64_tr_b16 a[6:7], v44 offset:6144
    v_mfma_f32_16x16x32_bf16 v[184:187], a[44:47], v[124:127], v[184:187]
    s_waitcnt lgkmcnt(8)
    v_mfma_f32_16x16x32_bf16 v[180:183], a[48:51], v[96:99], v[180:183]
    ds_read_b64_tr_b16 a[8:9], v44 offset:8192
    ds_read_b64_tr_b16 a[10:11], v44 offset:10240
    v_mfma_f32_16x16x32_bf16 v[180:183], a[52:55], v[104:107], v[180:183]
    s_waitcnt lgkmcnt(6)
    v_mfma_f32_16x16x32_bf16 v[180:183], a[56:59], v[112:115], v[180:183]
    ds_read_b64_tr_b16 a[12:13], v44 offset:12288
    ds_read_b64_tr_b16 a[14:15], v44 offset:14336
    v_mfma_f32_16x16x32_bf16 v[180:183], a[60:63], v[120:123], v[180:183]
    v_mfma_f32_16x16x32_bf16 v[188:191], a[48:51], v[100:103], v[188:191]
    ds_read_b64_tr_b16 a[16:17], v45 offset:0
    ds_read_b64_tr_b16 a[18:19], v45 offset:2048
    v_mfma_f32_16x16x32_bf16 v[188:191], a[52:55], v[108:111], v[188:191]
    v_mfma_f32_16x16x32_bf16 v[188:191], a[56:59], v[116:119], v[188:191]
    ds_read_b64_tr_b16 a[20:21], v45 offset:4096
    ds_read_b64_tr_b16 a[22:23], v45 offset:6144
    v_mfma_f32_16x16x32_bf16 v[188:191], a[60:63], v[124:127], v[188:191]
    s_waitcnt lgkmcnt(8)
    v_mfma_f32_16x16x32_bf16 v[128:131], a[0:3], v[64:67], 0
    ds_read_b64_tr_b16 a[24:25], v45 offset:8192
    ds_read_b64_tr_b16 a[26:27], v45 offset:10240
    v_mfma_f32_16x16x32_bf16 v[128:131], a[4:7], v[72:75], v[128:131]
    s_waitcnt lgkmcnt(6)
    v_add_u32 v44, 147456, v54
    v_mfma_f32_16x16x32_bf16 v[128:131], a[8:11], v[80:83], v[128:131]
    ds_read_b64_tr_b16 a[28:29], v45 offset:12288
    ds_read_b64_tr_b16 a[30:31], v45 offset:14336
    v_mfma_f32_16x16x32_bf16 v[128:131], a[12:15], v[88:91], v[128:131]
    v_xor_b32 v45, 32, v44
    v_cvt_pk_bf16_f32 v208, v160, v161
    v_mfma_f32_16x16x32_bf16 v[136:139], a[0:3], v[68:71], 0
    ds_read_b64_tr_b16 a[32:33], v46 offset:0
    ds_read_b64_tr_b16 a[34:35], v46 offset:2048
    v_mfma_f32_16x16x32_bf16 v[136:139], a[4:7], v[76:79], v[136:139]
    v_cvt_pk_bf16_f32 v209, v162, v163
    v_cvt_pk_bf16_f32 v210, v164, v165
    v_mfma_f32_16x16x32_bf16 v[136:139], a[8:11], v[84:87], v[136:139]
    ds_read_b64_tr_b16 a[36:37], v46 offset:4096
    ds_read_b64_tr_b16 a[38:39], v46 offset:6144
    v_mfma_f32_16x16x32_bf16 v[136:139], a[12:15], v[92:95], v[136:139]
    s_waitcnt lgkmcnt(8)
    v_cvt_pk_bf16_f32 v211, v166, v167
    v_cvt_pk_bf16_f32 v212, v168, v169
    v_mfma_f32_16x16x32_bf16 v[132:135], a[16:19], v[64:67], 0
    ds_read_b64_tr_b16 a[40:41], v46 offset:8192
    ds_read_b64_tr_b16 a[42:43], v46 offset:10240
    v_mfma_f32_16x16x32_bf16 v[132:135], a[20:23], v[72:75], v[132:135]
    s_waitcnt lgkmcnt(6)
    v_cvt_pk_bf16_f32 v213, v170, v171
    v_cvt_pk_bf16_f32 v214, v172, v173
    v_mfma_f32_16x16x32_bf16 v[132:135], a[24:27], v[80:83], v[132:135]
    ds_read_b64_tr_b16 a[44:45], v46 offset:12288
    ds_read_b64_tr_b16 a[46:47], v46 offset:14336
    v_mfma_f32_16x16x32_bf16 v[132:135], a[28:31], v[88:91], v[132:135]
    v_xor_b32 v46, 64, v44
    v_cvt_pk_bf16_f32 v215, v174, v175
    v_mfma_f32_16x16x32_bf16 v[140:143], a[16:19], v[68:71], 0
    buffer_store_dwordx4 v[192:195], v55, s[48:51], s67 offen offset:0 sc1
    ds_read_b64_tr_b16 a[48:49], v47 offset:0
    ds_read_b64_tr_b16 a[50:51], v47 offset:2048
    v_mfma_f32_16x16x32_bf16 v[140:143], a[20:23], v[76:79], v[140:143]
    v_cvt_pk_bf16_f32 v216, v176, v177
    v_cvt_pk_bf16_f32 v217, v178, v179
    v_mfma_f32_16x16x32_bf16 v[140:143], a[24:27], v[84:87], v[140:143]
    ds_read_b64_tr_b16 a[52:53], v47 offset:4096
    ds_read_b64_tr_b16 a[54:55], v47 offset:6144
    v_mfma_f32_16x16x32_bf16 v[140:143], a[28:31], v[92:95], v[140:143]
    s_waitcnt lgkmcnt(8)
    v_cvt_pk_bf16_f32 v218, v180, v181
    v_cvt_pk_bf16_f32 v219, v182, v183
    v_mfma_f32_16x16x32_bf16 v[144:147], a[32:35], v[64:67], 0
    ds_read_b64_tr_b16 a[56:57], v47 offset:8192
    ds_read_b64_tr_b16 a[58:59], v47 offset:10240
    v_mfma_f32_16x16x32_bf16 v[144:147], a[36:39], v[72:75], v[144:147]
    s_waitcnt lgkmcnt(6)
    v_cvt_pk_bf16_f32 v220, v184, v185
    v_cvt_pk_bf16_f32 v221, v186, v187
    v_mfma_f32_16x16x32_bf16 v[144:147], a[40:43], v[80:83], v[144:147]
    ds_read_b64_tr_b16 a[60:61], v47 offset:12288
    ds_read_b64_tr_b16 a[62:63], v47 offset:14336
    v_mfma_f32_16x16x32_bf16 v[144:147], a[44:47], v[88:91], v[144:147]
    v_xor_b32 v47, 96, v44
    v_cvt_pk_bf16_f32 v222, v188, v189
    v_mfma_f32_16x16x32_bf16 v[152:155], a[32:35], v[68:71], 0
    ds_read_b64_tr_b16 a[0:1], v44 offset:0
    ds_read_b64_tr_b16 a[2:3], v44 offset:2048
    v_mfma_f32_16x16x32_bf16 v[152:155], a[36:39], v[76:79], v[152:155]
    v_cvt_pk_bf16_f32 v223, v190, v191
    v_mfma_f32_16x16x32_bf16 v[152:155], a[40:43], v[84:87], v[152:155]
    ds_read_b64_tr_b16 a[4:5], v44 offset:4096
    ds_read_b64_tr_b16 a[6:7], v44 offset:6144
    v_mfma_f32_16x16x32_bf16 v[152:155], a[44:47], v[92:95], v[152:155]
    s_waitcnt lgkmcnt(8)
    v_mfma_f32_16x16x32_bf16 v[148:151], a[48:51], v[64:67], 0
    buffer_store_dwordx4 v[196:199], v55, s[48:51], s67 offen offset:1024 sc1
    ds_read_b64_tr_b16 a[8:9], v44 offset:8192
    ds_read_b64_tr_b16 a[10:11], v44 offset:10240
    v_mfma_f32_16x16x32_bf16 v[148:151], a[52:55], v[72:75], v[148:151]
    s_waitcnt lgkmcnt(6)
    v_mfma_f32_16x16x32_bf16 v[148:151], a[56:59], v[80:83], v[148:151]
    ds_read_b64_tr_b16 a[12:13], v44 offset:12288
    ds_read_b64_tr_b16 a[14:15], v44 offset:14336
    v_mfma_f32_16x16x32_bf16 v[148:151], a[60:63], v[88:91], v[148:151]
    v_mfma_f32_16x16x32_bf16 v[156:159], a[48:51], v[68:71], 0
    ds_read_b64_tr_b16 a[16:17], v45 offset:0
    ds_read_b64_tr_b16 a[18:19], v45 offset:2048
    v_mfma_f32_16x16x32_bf16 v[156:159], a[52:55], v[76:79], v[156:159]
    v_mfma_f32_16x16x32_bf16 v[156:159], a[56:59], v[84:87], v[156:159]
    ds_read_b64_tr_b16 a[20:21], v45 offset:4096
    ds_read_b64_tr_b16 a[22:23], v45 offset:6144
    v_mfma_f32_16x16x32_bf16 v[156:159], a[60:63], v[92:95], v[156:159]
    s_waitcnt lgkmcnt(8)
    v_mfma_f32_16x16x32_bf16 v[128:131], a[0:3], v[96:99], v[128:131]
    ds_read_b64_tr_b16 a[24:25], v45 offset:8192
    ds_read_b64_tr_b16 a[26:27], v45 offset:10240
    v_mfma_f32_16x16x32_bf16 v[128:131], a[4:7], v[104:107], v[128:131]
    s_waitcnt lgkmcnt(6)
    v_add_u32 v44, 0, v54
    v_mfma_f32_16x16x32_bf16 v[128:131], a[8:11], v[112:115], v[128:131]
    ds_read_b64_tr_b16 a[28:29], v45 offset:12288
    ds_read_b64_tr_b16 a[30:31], v45 offset:14336
    v_mfma_f32_16x16x32_bf16 v[128:131], a[12:15], v[120:123], v[128:131]
    v_xor_b32 v45, 32, v44
    v_mfma_f32_16x16x32_bf16 v[136:139], a[0:3], v[100:103], v[136:139]
    ds_read_b64_tr_b16 a[32:33], v46 offset:0
    ds_read_b64_tr_b16 a[34:35], v46 offset:2048
    v_mfma_f32_16x16x32_bf16 v[136:139], a[4:7], v[108:111], v[136:139]
    v_mfma_f32_16x16x32_bf16 v[136:139], a[8:11], v[116:119], v[136:139]
    buffer_store_dwordx4 v[200:203], v55, s[48:51], s67 offen offset:2048 sc1
    ds_read_b64_tr_b16 a[36:37], v46 offset:4096
    ds_read_b64_tr_b16 a[38:39], v46 offset:6144
    v_mfma_f32_16x16x32_bf16 v[136:139], a[12:15], v[124:127], v[136:139]
    s_waitcnt lgkmcnt(8)
    v_mfma_f32_16x16x32_bf16 v[132:135], a[16:19], v[96:99], v[132:135]
    ds_read_b64_tr_b16 a[40:41], v46 offset:8192
    ds_read_b64_tr_b16 a[42:43], v46 offset:10240
    v_mfma_f32_16x16x32_bf16 v[132:135], a[20:23], v[104:107], v[132:135]
    s_waitcnt lgkmcnt(6)
    v_mfma_f32_16x16x32_bf16 v[132:135], a[24:27], v[112:115], v[132:135]
    ds_read_b64_tr_b16 a[44:45], v46 offset:12288
    ds_read_b64_tr_b16 a[46:47], v46 offset:14336
    v_mfma_f32_16x16x32_bf16 v[132:135], a[28:31], v[120:123], v[132:135]
    v_xor_b32 v46, 64, v44
    v_mfma_f32_16x16x32_bf16 v[140:143], a[16:19], v[100:103], v[140:143]
    ds_read_b64_tr_b16 a[48:49], v47 offset:0
    ds_read_b64_tr_b16 a[50:51], v47 offset:2048
    v_mfma_f32_16x16x32_bf16 v[140:143], a[20:23], v[108:111], v[140:143]
    v_mfma_f32_16x16x32_bf16 v[140:143], a[24:27], v[116:119], v[140:143]
    ds_read_b64_tr_b16 a[52:53], v47 offset:4096
    ds_read_b64_tr_b16 a[54:55], v47 offset:6144
    v_mfma_f32_16x16x32_bf16 v[140:143], a[28:31], v[124:127], v[140:143]
    s_waitcnt lgkmcnt(8)
    v_mfma_f32_16x16x32_bf16 v[144:147], a[32:35], v[96:99], v[144:147]
    ds_read_b64_tr_b16 a[56:57], v47 offset:8192
    ds_read_b64_tr_b16 a[58:59], v47 offset:10240
    v_mfma_f32_16x16x32_bf16 v[144:147], a[36:39], v[104:107], v[144:147]
    s_waitcnt lgkmcnt(6)
    v_mfma_f32_16x16x32_bf16 v[144:147], a[40:43], v[112:115], v[144:147]
    buffer_store_dwordx4 v[204:207], v55, s[48:51], s67 offen offset:3072 sc1
    ds_read_b64_tr_b16 a[60:61], v47 offset:12288
    ds_read_b64_tr_b16 a[62:63], v47 offset:14336
    v_mfma_f32_16x16x32_bf16 v[144:147], a[44:47], v[120:123], v[144:147]
    s_add_u32 s67, s67, 12288
    v_xor_b32 v47, 96, v44
    v_mfma_f32_16x16x32_bf16 v[152:155], a[32:35], v[100:103], v[152:155]
    s_barrier
    ds_read_b64_tr_b16 a[0:1], v44 offset:0
    ds_read_b64_tr_b16 a[2:3], v44 offset:2048
    v_mfma_f32_16x16x32_bf16 v[152:155], a[36:39], v[108:111], v[152:155]
    s_cmp_eq_u32 s67, s66
    v_mfma_f32_16x16x32_bf16 v[152:155], a[40:43], v[116:119], v[152:155]
    s_cselect_b32 s67, s68, s67
    ds_read_b64_tr_b16 a[4:5], v44 offset:4096
    ds_read_b64_tr_b16 a[6:7], v44 offset:6144
    v_mfma_f32_16x16x32_bf16 v[152:155], a[44:47], v[124:127], v[152:155]
    s_waitcnt lgkmcnt(8)
    v_mfma_f32_16x16x32_bf16 v[148:151], a[48:51], v[96:99], v[148:151]
    ds_read_b64_tr_b16 a[8:9], v44 offset:8192
    ds_read_b64_tr_b16 a[10:11], v44 offset:10240
    v_mfma_f32_16x16x32_bf16 v[148:151], a[52:55], v[104:107], v[148:151]
    s_waitcnt lgkmcnt(6)
    v_mfma_f32_16x16x32_bf16 v[148:151], a[56:59], v[112:115], v[148:151]
    ds_read_b64_tr_b16 a[12:13], v44 offset:12288
    ds_read_b64_tr_b16 a[14:15], v44 offset:14336
    v_mfma_f32_16x16x32_bf16 v[148:151], a[60:63], v[120:123], v[148:151]
    v_mfma_f32_16x16x32_bf16 v[156:159], a[48:51], v[100:103], v[156:159]
    ds_read_b64_tr_b16 a[16:17], v45 offset:0
    ds_read_b64_tr_b16 a[18:19], v45 offset:2048
    v_mfma_f32_16x16x32_bf16 v[156:159], a[52:55], v[108:111], v[156:159]
    v_mfma_f32_16x16x32_bf16 v[156:159], a[56:59], v[116:119], v[156:159]
    buffer_store_dwordx4 v[208:211], v55, s[48:51], s67 offen offset:0 sc1
    ds_read_b64_tr_b16 a[20:21], v45 offset:4096
    ds_read_b64_tr_b16 a[22:23], v45 offset:6144
    v_mfma_f32_16x16x32_bf16 v[156:159], a[60:63], v[124:127], v[156:159]
    s_waitcnt lgkmcnt(8)
    v_mfma_f32_16x16x32_bf16 v[160:163], a[0:3], v[64:67], 0
    ds_read_b64_tr_b16 a[24:25], v45 offset:8192
    ds_read_b64_tr_b16 a[26:27], v45 offset:10240
    v_mfma_f32_16x16x32_bf16 v[160:163], a[4:7], v[72:75], v[160:163]
    s_waitcnt lgkmcnt(6)
    v_add_u32 v44, 16384, v54
    v_mfma_f32_16x16x32_bf16 v[160:163], a[8:11], v[80:83], v[160:163]
    ds_read_b64_tr_b16 a[28:29], v45 offset:12288
L_pg6:
    s_cbranch_execz L_w2_2
    ds_read_b64_tr_b16 a[30:31], v45 offset:14336
    v_mfma_f32_16x16x32_bf16 v[160:163], a[12:15], v[88:91], v[160:163]
    v_xor_b32 v45, 32, v44
    v_cvt_pk_bf16_f32 v224, v128, v129
    v_mfma_f32_16x16x32_bf16 v[168:171], a[0:3], v[68:71], 0
    ds_read_b64_tr_b16 a[32:33], v46 offset:0
    ds_read_b64_tr_b16 a[34:35], v46 offset:2048
    v_mfma_f32_16x16x32_bf16 v[168:171], a[4:7], v[76:79], v[168:171]
    v_cvt_pk_bf16_f32 v225, v130, v131
    v_cvt_pk_bf16_f32 v226, v132, v133
    v_mfma_f32_16x16x32_bf16 v[168:171], a[8:11], v[84:87], v[168:171]
    ds_read_b64_tr_b16 a[36:37], v46 offset:4096
    ds_read_b64_tr_b16 a[38:39], v46 offset:6144
    v_mfma_f32_16x16x32_bf16 v[168:171], a[12:15], v[92:95], v[168:171]
    s_waitcnt lgkmcnt(8)
    v_cvt_pk_bf16_f32 v227, v134, v135
    v_cvt_pk_bf16_f32 v228, v136, v137
    v_mfma_f32_16x16x32_bf16 v[164:167], a[16:19], v[64:67], 0
    ds_read_b64_tr_b16 a[40:41], v46 offset:8192
    ds_read_b64_tr_b16 a[42:43], v46 offset:10240
    v_mfma_f32_16x16x32_bf16 v[164:167], a[20:23], v[72:75], v[164:167]
    s_waitcnt lgkmcnt(6)
    v_cvt_pk_bf16_f32 v229, v138, v139
    v_cvt_pk_bf16_f32 v230, v140, v141
    v_mfma_f32_16x16x32_bf16 v[164:167], a[24:27], v[80:83], v[164:167]
    ds_read_b64_tr_b16 a[44:45], v46 offset:12288
    ds_read_b64_tr_b16 a[46:47], v46 offset:14336
    v_mfma_f32_16x16x32_bf16 v[164:167], a[28:31], v[88:91], v[164:167]
    v_xor_b32 v46, 64, v44
    v_cvt_pk_bf16_f32 v231, v142, v143
    v_mfma_f32_16x16x32_bf16 v[172:175], a[16:19], v[68:71], 0
    buffer_store_dwordx4 v[212:215], v55, s[48:51], s67 offen offset:1024 sc1
    ds_read_b64_tr_b16 a[48:49], v47 offset:0
    ds_read_b64_tr_b16 a[50:51], v47 offset:2048
    v_mfma_f32_16x16x32_bf16 v[172:175], a[20:23], v[76:79], v[172:175]
    v_cvt_pk_bf16_f32 v232, v144, v145
    v_cvt_pk_bf16_f32 v233, v146, v147
    v_mfma_f32_16x16x32_bf16 v[172:175], a[24:27], v[84:87], v[172:175]
    ds_read_b64_tr_b16 a[52:53], v47 offset:4096
    ds_read_b64_tr_b16 a[54:55], v47 offset:6144
    v_mfma_f32_16x16x32_bf16 v[172:175], a[28:31], v[92:95], v[172:175]
    s_waitcnt lgkmcnt(8)
    v_cvt_pk_bf16_f32 v234, v148, v149
    v_cvt_pk_bf16_f32 v235, v150, v151
    v_mfma_f32_16x16x32_bf16 v[176:179], a[32:35], v[64:67], 0
    ds_read_b64_tr_b16 a[56:57], v47 offset:8192
    ds_read_b64_tr_b16 a[58:59], v47 offset:10240
    v_mfma_f32_16x16x32_bf16 v[176:179], a[36:39], v[72:75], v[176:179]
    s_waitcnt lgkmcnt(6)
    v_cvt_pk_bf16_f32 v236, v152, v153
    v_cvt_pk_bf16_f32 v237, v154, v155
    v_mfma_f32_16x16x32_bf16 v[176:179], a[40:43], v[80:83], v[176:179]
    ds_read_b64_tr_b16 a[60:61], v47 offset:12288
    ds_read_b64_tr_b16 a[62:63], v47 offset:14336
    v_mfma_f32_16x16x32_bf16 v[176:179], a[44:47], v[88:91], v[176:179]
    v_xor_b32 v47, 96, v44
    v_cvt_pk_bf16_f32 v238, v156, v157
    v_mfma_f32_16x16x32_bf16 v[184:187], a[32:35], v[68:71], 0
    ds_read_b64_tr_b16 a[0:1], v44 offset:0
    ds_read_b64_tr_b16 a[2:3], v44 offset:2048
    v_mfma_f32_16x16x32_bf16 v[184:187], a[36:39], v[76:79], v[184:187]
    v_cvt_pk_bf16_f32 v239, v158, v159
    v_mfma_f32_16x16x32_bf16 v[184:187], a[40:43], v[84:87], v[184:187]
    ds_read_b64_tr_b16 a[4:5], v44 offset:4096
    ds_read_b64_tr_b16 a[6:7], v44 offset:6144
    v_mfma_f32_16x16x32_bf16 v[184:187], a[44:47], v[92:95], v[184:187]
    s_waitcnt lgkmcnt(8)
    v_mfma_f32_16x16x32_bf16 v[180:183], a[48:51], v[64:67], 0
    buffer_store_dwordx4 v[216:219], v55, s[48:51], s67 offen offset:2048 sc1
    ds_read_b64_tr_b16 a[8:9], v44 offset:8192
    ds_read_b64_tr_b16 a[10:11], v44 offset:10240
    v_mfma_f32_16x16x32_bf16 v[180:183], a[52:55], v[72:75], v[180:183]
    s_waitcnt lgkmcnt(6)
    v_mfma_f32_16x16x32_bf16 v[180:183], a[56:59], v[80:83], v[180:183]
    ds_read_b64_tr_b16 a[12:13], v44 offset:12288
    ds_read_b64_tr_b16 a[14:15], v44 offset:14336
    v_mfma_f32_16x16x32_bf16 v[180:183], a[60:63], v[88:91], v[180:183]
    v_mfma_f32_16x16x32_bf16 v[188:191], a[48:51], v[68:71], 0
    ds_read_b64_tr_b16 a[16:17], v45 offset:0
    ds_read_b64_tr_b16 a[18:19], v45 offset:2048
    v_mfma_f32_16x16x32_bf16 v[188:191], a[52:55], v[76:79], v[188:191]
    v_mfma_f32_16x16x32_bf16 v[188:191], a[56:59], v[84:87], v[188:191]
    ds_read_b64_tr_b16 a[20:21], v45 offset:4096
    ds_read_b64_tr_b16 a[22:23], v45 offset:6144
    v_mfma_f32_16x16x32_bf16 v[188:191], a[60:63], v[92:95], v[188:191]
    s_waitcnt lgkmcnt(8)
    v_mfma_f32_16x16x32_bf16 v[160:163], a[0:3], v[96:99], v[160:163]
    ds_read_b64_tr_b16 a[24:25], v45 offset:8192
    ds_read_b64_tr_b16 a[26:27], v45 offset:10240
    v_mfma_f32_16x16x32_bf16 v[160:163], a[4:7], v[104:107], v[160:163]
    s_waitcnt lgkmcnt(6)
    v_add_u32 v44, 32768, v54
    v_mfma_f32_16x16x32_bf16 v[160:163], a[8:11], v[112:115], v[160:163]
    ds_read_b64_tr_b16 a[28:29], v45 offset:12288
    ds_read_b64_tr_b16 a[30:31], v45 offset:14336
    v_mfma_f32_16x16x32_bf16 v[160:163], a[12:15], v[120:123], v[160:163]
    v_xor_b32 v45, 32, v44
    v_mfma_f32_16x16x32_bf16 v[168:171], a[0:3], v[100:103], v[168:171]
    buffer_store_dwordx4 v[220:223], v55, s[48:51], s67 offen offset:3072 sc1
    ds_read_b64_tr_b16 a[32:33], v46 offset:0
    ds_read_b64_tr_b16 a[34:35], v46 offset:2048
    v_mfma_f32_16x16x32_bf16 v[168:171], a[4:7], v[108:111], v[168:171]
    s_add_u32 s67, s67, 12288
    v_mfma_f32_16x16x32_bf16 v[168:171], a[8:11], v[116:119], v[168:171]
    s_cmp_eq_u32 s67, s66
    ds_read_b64_tr_b16 a[36:37], v46 offset:4096
    ds_read_b64_tr_b16 a[38:39], v46 offset:6144
    v_mfma_f32_16x16x32_bf16 v[168:171], a[12:15], v[124:127], v[168:171]
    s_waitcnt lgkmcnt(8)
    v_mfma_f32_16x16x32_bf16 v[164:167], a[16:19], v[96:99], v[164:167]
    s_cselect_b32 s67, s68, s67
    ds_read_b64_tr_b16 a[40:41], v46 offset:8192
    ds_read_b64_tr_b16 a[42:43], v46 offset:10240
    v_mfma_f32_16x16x32_bf16 v[164:167], a[20:23], v[104:107], v[164:167]
    s_waitcnt lgkmcnt(6)
    v_mfma_f32_16x16x32_bf16 v[164:167], a[24:27], v[112:115], v[164:167]
    ds_read_b64_tr_b16 a[44:45], v46 offset:12288
    ds_read_b64_tr_b16 a[46:47], v46 offset:14336
    v_mfma_f32_16x16x32_bf16 v[164:167], a[28:31], v[120:123], v[164:167]
    v_xor_b32 v46, 64, v44
    v_mfma_f32_16x16x32_bf16 v[172:175], a[16:19], v[100:103], v[172:175]
    ds_read_b64_tr_b16 a[48:49], v47 offset:0
    ds_read_b64_tr_b16 a[50:51], v47 offset:2048
    v_mfma_f32_16x16x32_bf16 v[172:175], a[20:23], v[108:111], v[172:175]
    v_mfma_f32_16x16x32_bf16 v[172:175], a[24:27], v[116:119], v[172:175]
    ds_read_b64_tr_b16 a[52:53], v47 offset:4096
    ds_read_b64_tr_b16 a[54:55], v47 offset:6144
    v_mfma_f32_16x16x32_bf16 v[172:175], a[28:31], v[124:127], v[172:175]
    s_waitcnt lgkmcnt(8)
    v_mfma_f32_16x16x32_bf16 v[176:179], a[32:35], v[96:99], v[176:179]
    ds_read_b64_tr_b16 a[56:57], v47 offset:8192
    ds_read_b64_tr_b16 a[58:59], v47 offset:10240
    v_mfma_f32_16x16x32_bf16 v[176:179], a[36:39], v[104:107], v[176:179]
    s_waitcnt lgkmcnt(6)
    v_mfma_f32_16x16x32_bf16 v[176:179], a[40:43], v[112:115], v[176:179]
    buffer_store_dwordx4 v[224:227], v55, s[48:51], s67 offen offset:0 sc1
    ds_read_b64_tr_b16 a[60:61], v47 offset:12288
    ds_read_b64_tr_b16 a[62:63], v47 offset:14336
    v_mfma_f32_16x16x32_bf16 v[176:179], a[44:47], v[120:123], v[176:179]
    v_xor_b32 v47, 96, v44
    v_mfma_f32_16x16x32_bf16 v[184:187], a[32:35], v[100:103], v[184:187]
    ds_read_b64_tr_b16 a[0:1], v44 offset:0
    ds_read_b64_tr_b16 a[2:3], v44 offset:2048
    v_mfma_f32_16x16x32_bf16 v[184:187], a[36:39], v[108:111], v[184:187]
    v_mfma_f32_16x16x32_bf16 v[184:187], a[40:43], v[116:119], v[184:187]
    ds_read_b64_tr_b16 a[4:5], v44 offset:4096
    ds_read_b64_tr_b16 a[6:7], v44 offset:6144
    v_mfma_f32_16x16x32_bf16 v[184:187], a[44:47], v[124:127], v[184:187]
    s_waitcnt lgkmcnt(8)
    v_mfma_f32_16x16x32_bf16 v[180:183], a[48:51], v[96:99], v[180:183]
    ds_read_b64_tr_b16 a[8:9], v44 offset:8192
    ds_read_b64_tr_b16 a[10:11], v44 offset:10240
    v_mfma_f32_16x16x32_bf16 v[180:183], a[52:55], v[104:107], v[180:183]
    s_waitcnt lgkmcnt(6)
    v_mfma_f32_16x16x32_bf16 v[180:183], a[56:59], v[112:115], v[180:183]
    ds_read_b64_tr_b16 a[12:13], v44 offset:12288
    ds_read_b64_tr_b16 a[14:15], v44 offset:14336
    v_mfma_f32_16x16x32_bf16 v[180:183], a[60:63], v[120:123], v[180:183]
    v_mfma_f32_16x16x32_bf16 v[188:191], a[48:51], v[100:103], v[188:191]
    ds_read_b64_tr_b16 a[16:17], v45 offset:0
    ds_read_b64_tr_b16 a[18:19], v45 offset:2048
    v_mfma_f32_16x16x32_bf16 v[188:191], a[52:55], v[108:111], v[188:191]
    v_mfma_f32_16x16x32_bf16 v[188:191], a[56:59], v[116:119], v[188:191]
    buffer_store_dwordx4 v[228:231], v55, s[48:51], s67 offen offset:1024 sc1
    ds_read_b64_tr_b16 a[20:21], v45 offset:4096
    ds_read_b64_tr_b16 a[22:23], v45 offset:6144
    v_mfma_f32_16x16x32_bf16 v[188:191], a[60:63], v[124:127], v[188:191]
    s_waitcnt lgkmcnt(8)
    v_mfma_f32_16x16x32_bf16 v[128:131], a[0:3], v[64:67], 0
    ds_read_b64_tr_b16 a[24:25], v45 offset:8192
    ds_read_b64_tr_b16 a[26:27], v45 offset:10240
    v_mfma_f32_16x16x32_bf16 v[128:131], a[4:7], v[72:75], v[128:131]
    s_waitcnt lgkmcnt(6)
    v_add_u32 v44, 49152, v54
    v_mfma_f32_16x16x32_bf16 v[128:131], a[8:11], v[80:83], v[128:131]
    ds_read_b64_tr_b16 a[28:29], v45 offset:12288
    ds_read_b64_tr_b16 a[30:31], v45 offset:14336
    v_mfma_f32_16x16x32_bf16 v[128:131], a[12:15], v[88:91], v[128:131]
    v_xor_b32 v45, 32, v44
    v_cvt_pk_bf16_f32 v240, v160, v161
    v_mfma_f32_16x16x32_bf16 v[136:139], a[0:3], v[68:71], 0
    ds_read_b64_tr_b16 a[32:33], v46 offset:0
    ds_read_b64_tr_b16 a[34:35], v46 offset:2048
    v_mfma_f32_16x16x32_bf16 v[136:139], a[4:7], v[76:79], v[136:139]
    v_cvt_pk_bf16_f32 v241, v162, v163
    v_cvt_pk_bf16_f32 v242, v164, v165
    v_mfma_f32_16x16x32_bf16 v[136:139], a[8:11], v[84:87], v[136:139]
    ds_read_b64_tr_b16 a[36:37], v46 offset:4096
    ds_read_b64_tr_b16 a[38:39], v46 offset:6144
    v_mfma_f32_16x16x32_bf16 v[136:139], a[12:15], v[92:95], v[136:139]
    s_waitcnt lgkmcnt(8)
    v_cvt_pk_bf16_f32 v243, v166, v167
    v_cvt_pk_bf16_f32 v244, v168, v169
    v_mfma_f32_16x16x32_bf16 v[132:135], a[16:19], v[64:67], 0
    ds_read_b64_tr_b16 a[40:41], v46 offset:8192
    ds_read_b64_tr_b16 a[42:43], v46 offset:10240
    v_mfma_f32_16x16x32_bf16 v[132:135], a[20:23], v[72:75], v[132:135]
    s_waitcnt lgkmcnt(6)
    v_cvt_pk_bf16_f32 v245, v170, v171
    v_cvt_pk_bf16_f32 v246, v172, v173
    v_mfma_f32_16x16x32_bf16 v[132:135], a[24:27], v[80:83], v[132:135]
    buffer_store_dwordx4 v[232:235], v55, s[48:51], s67 offen offset:2048 sc1
    ds_read_b64_tr_b16 a[44:45], v46 offset:12288
    ds_read_b64_tr_b16 a[46:47], v46 offset:14336
    v_mfma_f32_16x16x32_bf16 v[132:135], a[28:31], v[88:91], v[132:135]
    v_xor_b32 v46, 64, v44
    v_cvt_pk_bf16_f32 v247, v174, v175
    v_mfma_f32_16x16x32_bf16 v[140:143], a[16:19], v[68:71], 0
    ds_read_b64_tr_b16 a[48:49], v47 offset:0
    ds_read_b64_tr_b16 a[50:51], v47 offset:2048
    v_mfma_f32_16x16x32_bf16 v[140:143], a[20:23], v[76:79], v[140:143]
    v_cvt_pk_bf16_f32 v248, v176, v177
    v_cvt_pk_bf16_f32 v249, v178, v179
    v_mfma_f32_16x16x32_bf16 v[140:143], a[24:27], v[84:87], v[140:143]
    ds_read_b64_tr_b16 a[52:53], v47 offset:4096
    ds_read_b64_tr_b16 a[54:55], v47 offset:6144
    v_mfma_f32_16x16x32_bf16 v[140:143], a[28:31], v[92:95], v[140:143]
    s_waitcnt lgkmcnt(8)
    v_cvt_pk_bf16_f32 v250, v180, v181
    v_cvt_pk_bf16_f32 v251, v182, v183
    v_mfma_f32_16x16x32_bf16 v[144:147], a[32:35], v[64:67], 0
    ds_read_b64_tr_b16 a[56:57], v47 offset:8192
    ds_read_b64_tr_b16 a[58:59], v47 offset:10240
    v_mfma_f32_16x16x32_bf16 v[144:147], a[36:39], v[72:75], v[144:147]
    s_waitcnt lgkmcnt(6)
    v_cvt_pk_bf16_f32 v252, v184, v185
    v_cvt_pk_bf16_f32 v253, v186, v187
    v_mfma_f32_16x16x32_bf16 v[144:147], a[40:43], v[80:83], v[144:147]
    ds_read_b64_tr_b16 a[60:61], v47 offset:12288
    ds_read_b64_tr_b16 a[62:63], v47 offset:14336
    v_mfma_f32_16x16x32_bf16 v[144:147], a[44:47], v[88:91], v[144:147]
    v_xor_b32 v47, 96, v44
    v_cvt_pk_bf16_f32 v254, v188, v189
    v_mfma_f32_16x16x32_bf16 v[152:155], a[32:35], v[68:71], 0
    ds_read_b64_tr_b16 a[0:1], v44 offset:0
    ds_read_b64_tr_b16 a[2:3], v44 offset:2048
    v_mfma_f32_16x16x32_bf16 v[152:155], a[36:39], v[76:79], v[152:155]
    v_cvt_pk_bf16_f32 v255, v190, v191
    v_mfma_f32_16x16x32_bf16 v[152:155], a[40:43], v[84:87], v[152:155]
    ds_read_b64_tr_b16 a[4:5], v44 offset:4096
    ds_read_b64_tr_b16 a[6:7], v44 offset:6144
    v_mfma_f32_16x16x32_bf16 v[152:155], a[44:47], v[92:95], v[152:155]
    s_waitcnt lgkmcnt(8)
    v_mfma_f32_16x16x32_bf16 v[148:151], a[48:51], v[64:67], 0
    buffer_store_dwordx4 v[236:239], v55, s[48:51], s67 offen offset:3072 sc1
    ds_read_b64_tr_b16 a[8:9], v44 offset:8192
    ds_read_b64_tr_b16 a[10:11], v44 offset:10240
    v_mfma_f32_16x16x32_bf16 v[148:151], a[52:55], v[72:75], v[148:151]
    s_waitcnt lgkmcnt(6)
    v_mfma_f32_16x16x32_bf16 v[148:151], a[56:59], v[80:83], v[148:151]
    s_add_u32 s67, s67, 12288
    ds_read_b64_tr_b16 a[12:13], v44 offset:12288
    ds_read_b64_tr_b16 a[14:15], v44 offset:14336
    v_mfma_f32_16x16x32_bf16 v[148:151], a[60:63], v[88:91], v[148:151]
    s_cmp_eq_u32 s67, s66
    v_mfma_f32_16x16x32_bf16 v[156:159], a[48:51], v[68:71], 0
    s_cselect_b32 s67, s68, s67
    ds_read_b64_tr_b16 a[16:17], v45 offset:0
    ds_read_b64_tr_b16 a[18:19], v45 offset:2048
    v_mfma_f32_16x16x32_bf16 v[156:159], a[52:55], v[76:79], v[156:159]
    v_mfma_f32_16x16x32_bf16 v[156:159], a[56:59], v[84:87], v[156:159]
    ds_read_b64_tr_b16 a[20:21], v45 offset:4096
    ds_read_b64_tr_b16 a[22:23], v45 offset:6144
    v_mfma_f32_16x16x32_bf16 v[156:159], a[60:63], v[92:95], v[156:159]
    s_waitcnt lgkmcnt(8)
    v_mfma_f32_16x16x32_bf16 v[128:131], a[0:3], v[96:99], v[128:131]
    ds_read_b64_tr_b16 a[24:25], v45 offset:8192
    ds_read_b64_tr_b16 a[26:27], v45 offset:10240
    v_mfma_f32_16x16x32_bf16 v[128:131], a[4:7], v[104:107], v[128:131]
    s_waitcnt lgkmcnt(6)
    v_add_u32 v44, 65536, v54
    v_mfma_f32_16x16x32_bf16 v[128:131], a[8:11], v[112:115], v[128:131]
    ds_read_b64_tr_b16 a[28:29], v45 offset:12288
    ds_read_b64_tr_b16 a[30:31], v45 offset:14336
    v_mfma_f32_16x16x32_bf16 v[128:131], a[12:15], v[120:123], v[128:131]
    v_xor_b32 v45, 32, v44
    v_mfma_f32_16x16x32_bf16 v[136:139], a[0:3], v[100:103], v[136:139]
    buffer_store_dwordx4 v[240:243], v55, s[48:51], s67 offen offset:0 sc1
    ds_read_b64_tr_b16 a[32:33], v46 offset:0
    ds_read_b64_tr_b16 a[34:35], v46 offset:2048
    v_mfma_f32_16x16x32_bf16 v[136:139], a[4:7], v[108:111], v[136:139]
    v_mfma_f32_16x16x32_bf16 v[136:139], a[8:11], v[116:119], v[136:139]
    ds_read_b64_tr_b16 a[36:37], v46 offset:4096
    ds_read_b64_tr_b16 a[38:39], v46 offset:6144
    v_mfma_f32_16x16x32_bf16 v[136:139], a[12:15], v[124:127], v[136:139]
    s_waitcnt lgkmcnt(8)
    v_mfma_f32_16x16x32_bf16 v[132:135], a[16:19], v[96:99], v[132:135]
    ds_read_b64_tr_b16 a[40:41], v46 offset:8192
    ds_read_b64_tr_b16 a[42:43], v46 offset:10240
    v_mfma_f32_16x16x32_bf16 v[132:135], a[20:23], v[104:107], v[132:135]
    s_waitcnt lgkmcnt(6)
    v_mfma_f32_16x16x32_bf16 v[132:135], a[24:27], v[112:115], v[132:135]
    ds_read_b64_tr_b16 a[44:45], v46 offset:12288
    ds_read_b64_tr_b16 a[46:47], v46 offset:14336
    v_mfma_f32_16x16x32_bf16 v[132:135], a[28:31], v[120:123], v[132:135]
    v_xor_b32 v46, 64, v44
    v_mfma_f32_16x16x32_bf16 v[140:143], a[16:19], v[100:103], v[140:143]
    ds_read_b64_tr_b16 a[48:49], v47 offset:0
    ds_read_b64_tr_b16 a[50:51], v47 offset:2048
    v_mfma_f32_16x16x32_bf16 v[140:143], a[20:23], v[108:111], v[140:143]
    v_mfma_f32_16x16x32_bf16 v[140:143], a[24:27], v[116:119], v[140:143]
    ds_read_b64_tr_b16 a[52:53], v47 offset:4096
    ds_read_b64_tr_b16 a[54:55], v47 offset:6144
    v_mfma_f32_16x16x32_bf16 v[140:143], a[28:31], v[124:127], v[140:143]
    s_waitcnt lgkmcnt(8)
    v_mfma_f32_16x16x32_bf16 v[144:147], a[32:35], v[96:99], v[144:147]
    ds_read_b64_tr_b16 a[56:57], v47 offset:8192
    ds_read_b64_tr_b16 a[58:59], v47 offset:10240
    v_mfma_f32_16x16x32_bf16 v[144:147], a[36:39], v[104:107], v[144:147]
    s_waitcnt lgkmcnt(6)
    v_mfma_f32_16x16x32_bf16 v[144:147], a[40:43], v[112:115], v[144:147]
    buffer_store_dwordx4 v[244:247], v55, s[48:51], s67 offen offset:1024 sc1
    ds_read_b64_tr_b16 a[60:61], v47 offset:12288
    ds_read_b64_tr_b16 a[62:63], v47 offset:14336
    v_mfma_f32_16x16x32_bf16 v[144:147], a[44:47], v[120:123], v[144:147]
    v_xor_b32 v47, 96, v44
    v_mfma_f32_16x16x32_bf16 v[152:155], a[32:35], v[100:103], v[152:155]
    s_barrier
    ds_read_b64_tr_b16 a[0:1], v44 offset:0
    ds_read_b64_tr_b16 a[2:3], v44 offset:2048
    v_mfma_f32_16x16x32_bf16 v[152:155], a[36:39], v[108:111], v[152:155]
    v_mfma_f32_16x16x32_bf16 v[152:155], a[40:43], v[116:119], v[152:155]
    ds_read_b64_tr_b16 a[4:5], v44 offset:4096
    ds_read_b64_tr_b16 a[6:7], v44 offset:6144
    v_mfma_f32_16x16x32_bf16 v[152:155], a[44:47], v[124:127], v[152:155]
    s_waitcnt lgkmcnt(8)
    v_mfma_f32_16x16x32_bf16 v[148:151], a[48:51], v[96:99], v[148:151]
    ds_read_b64_tr_b16 a[8:9], v44 offset:8192
    ds_read_b64_tr_b16 a[10:11], v44 offset:10240
    v_mfma_f32_16x16x32_bf16 v[148:151], a[52:55], v[104:107], v[148:151]
    s_waitcnt lgkmcnt(6)
    v_mfma_f32_16x16x32_bf16 v[148:151], a[56:59], v[112:115], v[148:151]
    ds_read_b64_tr_b16 a[12:13], v44 offset:12288
    ds_read_b64_tr_b16 a[14:15], v44 offset:14336
    v_mfma_f32_16x16x32_bf16 v[148:151], a[60:63], v[120:123], v[148:151]
    v_mfma_f32_16x16x32_bf16 v[156:159], a[48:51], v[100:103], v[156:159]
    ds_read_b64_tr_b16 a[16:17], v45 offset:0
    ds_read_b64_tr_b16 a[18:19], v45 offset:2048
    v_mfma_f32_16x16x32_bf16 v[156:159], a[52:55], v[108:111], v[156:159]
    v_mfma_f32_16x16x32_bf16 v[156:159], a[56:59], v[116:119], v[156:159]
    buffer_store_dwordx4 v[248:251], v55, s[48:51], s67 offen offset:2048 sc1
    ds_read_b64_tr_b16 a[20:21], v45 offset:4096
    ds_read_b64_tr_b16 a[22:23], v45 offset:6144
    v_mfma_f32_16x16x32_bf16 v[156:159], a[60:63], v[124:127], v[156:159]
    s_waitcnt lgkmcnt(8)
    v_mfma_f32_16x16x32_bf16 v[160:163], a[0:3], v[64:67], 0
    ds_read_b64_tr_b16 a[24:25], v45 offset:8192
    ds_read_b64_tr_b16 a[26:27], v45 offset:10240
    v_mfma_f32_16x16x32_bf16 v[160:163], a[4:7], v[72:75], v[160:163]
    s_waitcnt lgkmcnt(6)
    v_add_u32 v44, 81920, v54
    v_mfma_f32_16x16x32_bf16 v[160:163], a[8:11], v[80:83], v[160:163]
    ds_read_b64_tr_b16 a[28:29], v45 offset:12288
    ds_read_b64_tr_b16 a[30:31], v45 offset:14336
    v_mfma_f32_16x16x32_bf16 v[160:163], a[12:15], v[88:91], v[160:163]
    v_xor_b32 v45, 32, v44
    v_cvt_pk_bf16_f32 v0, v128, v129
    v_mfma_f32_16x16x32_bf16 v[168:171], a[0:3], v[68:71], 0
    ds_read_b64_tr_b16 a[32:33], v46 offset:0
    ds_read_b64_tr_b16 a[34:35], v46 offset:2048
    v_mfma_f32_16x16x32_bf16 v[168:171], a[4:7], v[76:79], v[168:171]
    v_cvt_pk_bf16_f32 v1, v130, v131
    v_cvt_pk_bf16_f32 v2, v132, v133
    v_mfma_f32_16x16x32_bf16 v[168:171], a[8:11], v[84:87], v[168:171]
    ds_read_b64_tr_b16 a[36:37], v46 offset:4096
    ds_read_b64_tr_b16 a[38:39], v46 offset:6144
    v_mfma_f32_16x16x32_bf16 v[168:171], a[12:15], v[92:95], v[168:171]
    s_waitcnt lgkmcnt(8)
    v_cvt_pk_bf16_f32 v3, v134, v135
    v_cvt_pk_bf16_f32 v4, v136, v137
    v_mfma_f32_16x16x32_bf16 v[164:167], a[16:19], v[64:67], 0
    ds_read_b64_tr_b16 a[40:41], v46 offset:8192
    ds_read_b64_tr_b16 a[42:43], v46 offset:10240
    v_mfma_f32_16x16x32_bf16 v[164:167], a[20:23], v[72:75], v[164:167]
    s_waitcnt lgkmcnt(6)
    v_cvt_pk_bf16_f32 v5, v138, v139
    v_cvt_pk_bf16_f32 v6, v140, v141
    v_mfma_f32_16x16x32_bf16 v[164:167], a[24:27], v[80:83], v[164:167]
    buffer_store_dwordx4 v[252:255], v55, s[48:51], s67 offen offset:3072 sc1
    ds_read_b64_tr_b16 a[44:45], v46 offset:12288
    ds_read_b64_tr_b16 a[46:47], v46 offset:14336
    v_mfma_f32_16x16x32_bf16 v[164:167], a[28:31], v[88:91], v[164:167]
    s_add_u32 s67, s67, 12288
    v_xor_b32 v46, 64, v44
    v_cvt_pk_bf16_f32 v7, v142, v143
    v_mfma_f32_16x16x32_bf16 v[172:175], a[16:19], v[68:71], 0
    s_cmp_eq_u32 s67, s66
    ds_read_b64_tr_b16 a[48:49], v47 offset:0
    ds_read_b64_tr_b16 a[50:51], v47 offset:2048
    v_mfma_f32_16x16x32_bf16 v[172:175], a[20:23], v[76:79], v[172:175]
    s_cselect_b32 s67, s68, s67
    v_cvt_pk_bf16_f32 v8, v144, v145
    v_cvt_pk_bf16_f32 v9, v146, v147
    v_mfma_f32_16x16x32_bf16 v[172:175], a[24:27], v[84:87], v[172:175]
    ds_read_b64_tr_b16 a[52:53], v47 offset:4096
    ds_read_b64_tr_b16 a[54:55], v47 offset:6144
    v_mfma_f32_16x16x32_bf16 v[172:175], a[28:31], v[92:95], v[172:175]
    s_waitcnt lgkmcnt(8)
    v_cvt_pk_bf16_f32 v10, v148, v149
    v_cvt_pk_bf16_f32 v11, v150, v151
    v_mfma_f32_16x16x32_bf16 v[176:179], a[32:35], v[64:67], 0
    ds_read_b64_tr_b16 a[56:57], v47 offset:8192
    ds_read_b64_tr_b16 a[58:59], v47 offset:10240
    v_mfma_f32_16x16x32_bf16 v[176:179], a[36:39], v[72:75], v[176:179]
    s_waitcnt lgkmcnt(6)
    v_cvt_pk_bf16_f32 v12, v152, v153
    v_cvt_pk_bf16_f32 v13, v154, v155
    v_mfma_f32_16x16x32_bf16 v[176:179], a[40:43], v[80:83], v[176:179]
    ds_read_b64_tr_b16 a[60:61], v47 offset:12288
    ds_read_b64_tr_b16 a[62:63], v47 offset:14336
    v_mfma_f32_16x16x32_bf16 v[176:179], a[44:47], v[88:91], v[176:179]
    v_xor_b32 v47, 96, v44
    v_cvt_pk_bf16_f32 v14, v156, v157
    v_mfma_f32_16x16x32_bf16 v[184:187], a[32:35], v[68:71], 0
    ds_read_b64_tr_b16 a[0:1], v44 offset:0
    ds_read_b64_tr_b16 a[2:3], v44 offset:2048
    v_mfma_f32_16x16x32_bf16 v[184:187], a[36:39], v[76:79], v[184:187]
    v_cvt_pk_bf16_f32 v15, v158, v159
    v_mfma_f32_16x16x32_bf16 v[184:187], a[40:43], v[84:87], v[184:187]
    ds_read_b64_tr_b16 a[4:5], v44 offset:4096
    ds_read_b64_tr_b16 a[6:7], v44 offset:6144
    v_mfma_f32_16x16x32_bf16 v[184:187], a[44:47], v[92:95], v[184:187]
    s_waitcnt lgkmcnt(8)
    v_mfma_f32_16x16x32_bf16 v[180:183], a[48:51], v[64:67], 0
    buffer_store_dwordx4 v[0:3], v55, s[48:51], s67 offen offset:0 sc1
    ds_read_b64_tr_b16 a[8:9], v44 offset:8192
    ds_read_b64_tr_b16 a[10:11], v44 offset:10240
    v_mfma_f32_16x16x32_bf16 v[180:183], a[52:55], v[72:75], v[180:183]
    s_waitcnt lgkmcnt(6)
    v_mfma_f32_16x16x32_bf16 v[180:183], a[56:59], v[80:83], v[180:183]
    ds_read_b64_tr_b16 a[12:13], v44 offset:12288
    ds_read_b64_tr_b16 a[14:15], v44 offset:14336
    v_mfma_f32_16x16x32_bf16 v[180:183], a[60:63], v[88:91], v[180:183]
    v_mfma_f32_16x16x32_bf16 v[188:191], a[48:51], v[68:71], 0
    ds_read_b64_tr_b16 a[16:17], v45 offset:0
    ds_read_b64_tr_b16 a[18:19], v45 offset:2048
    v_mfma_f32_16x16x32_bf16 v[188:191], a[52:55], v[76:79], v[188:191]
    v_mfma_f32_16x16x32_bf16 v[188:191], a[56:59], v[84:87], v[188:191]
    ds_read_b64_tr_b16 a[20:21], v45 offset:4096
    ds_read_b64_tr_b16 a[22:23], v45 offset:6144
    v_mfma_f32_16x16x32_bf16 v[188:191], a[60:63], v[92:95], v[188:191]
    s_waitcnt lgkmcnt(8)
    v_mfma_f32_16x16x32_bf16 v[160:163], a[0:3], v[96:99], v[160:163]
    ds_read_b64_tr_b16 a[24:25], v45 offset:8192
    ds_read_b64_tr_b16 a[26:27], v45 offset:10240
    v_mfma_f32_16x16x32_bf16 v[160:163], a[4:7], v[104:107], v[160:163]
    s_waitcnt lgkmcnt(6)
    v_add_u32 v44, 98304, v54
    v_mfma_f32_16x16x32_bf16 v[160:163], a[8:11], v[112:115], v[160:163]
    ds_read_b64_tr_b16 a[28:29], v45 offset:12288
    ds_read_b64_tr_b16 a[30:31], v45 offset:14336
    v_mfma_f32_16x16x32_bf16 v[160:163], a[12:15], v[120:123], v[160:163]
    v_xor_b32 v45, 32, v44
    v_mfma_f32_16x16x32_bf16 v[168:171], a[0:3], v[100:103], v[168:171]
    buffer_store_dwordx4 v[4:7], v55, s[48:51], s67 offen offset:1024 sc1
    ds_read_b64_tr_b16 a[32:33], v46 offset:0
    ds_read_b64_tr_b16 a[34:35], v46 offset:2048
    v_mfma_f32_16x16x32_bf16 v[168:171], a[4:7], v[108:111], v[168:171]
    v_mfma_f32_16x16x32_bf16 v[168:171], a[8:11], v[116:119], v[168:171]
    ds_read_b64_tr_b16 a[36:37], v46 offset:4096
    ds_read_b64_tr_b16 a[38:39], v46 offset:6144
    v_mfma_f32_16x16x32_bf16 v[168:171], a[12:15], v[124:127], v[168:171]
    s_waitcnt lgkmcnt(8)
    v_mfma_f32_16x16x32_bf16 v[164:167], a[16:19], v[96:99], v[164:167]
    ds_read_b64_tr_b16 a[40:41], v46 offset:8192
    ds_read_b64_tr_b16 a[42:43], v46 offset:10240
    v_mfma_f32_16x16x32_bf16 v[164:167], a[20:23], v[104:107], v[164:167]
    s_waitcnt lgkmcnt(6)
    v_mfma_f32_16x16x32_bf16 v[164:167], a[24:27], v[112:115], v[164:167]
    ds_read_b64_tr_b16 a[44:45], v46 offset:12288
    ds_read_b64_tr_b16 a[46:47], v46 offset:14336
    v_mfma_f32_16x16x32_bf16 v[164:167], a[28:31], v[120:123], v[164:167]
    v_xor_b32 v46, 64, v44
    v_mfma_f32_16x16x32_bf16 v[172:175], a[16:19], v[100:103], v[172:175]
    ds_read_b64_tr_b16 a[48:49], v47 offset:0
    ds_read_b64_tr_b16 a[50:51], v47 offset:2048
    v_mfma_f32_16x16x32_bf16 v[172:175], a[20:23], v[108:111], v[172:175]
    v_mfma_f32_16x16x32_bf16 v[172:175], a[24:27], v[116:119], v[172:175]
    ds_read_b64_tr_b16 a[52:53], v47 offset:4096
    ds_read_b64_tr_b16 a[54:55], v47 offset:6144
    v_mfma_f32_16x16x32_bf16 v[172:175], a[28:31], v[124:127], v[172:175]
    s_waitcnt lgkmcnt(8)
    v_mfma_f32_16x16x32_bf16 v[176:179], a[32:35], v[96:99], v[176:179]
    buffer_store_dwordx4 v[8:11], v55, s[48:51], s67 offen offset:2048 sc1
    ds_read_b64_tr_b16 a[56:57], v47 offset:8192
    ds_read_b64_tr_b16 a[58:59], v47 offset:10240
    v_mfma_f32_16x16x32_bf16 v[176:179], a[36:39], v[104:107], v[176:179]
    s_waitcnt lgkmcnt(6)
    v_mfma_f32_16x16x32_bf16 v[176:179], a[40:43], v[112:115], v[176:179]
    ds_read_b64_tr_b16 a[60:61], v47 offset:12288
    ds_read_b64_tr_b16 a[62:63], v47 offset:14336
    v_mfma_f32_16x16x32_bf16 v[176:179], a[44:47], v[120:123], v[176:179]
    v_xor_b32 v47, 96, v44
    v_mfma_f32_16x16x32_bf16 v[184:187], a[32:35], v[100:103], v[184:187]
    ds_read_b64_tr_b16 a[0:1], v44 offset:0
    ds_read_b64_tr_b16 a[2:3], v44 offset:2048
    v_mfma_f32_16x16x32_bf16 v[184:187], a[36:39], v[108:111], v[184:187]
    v_mfma_f32_16x16x32_bf16 v[184:187], a[40:43], v[116:119], v[184:187]
    ds_read_b64_tr_b16 a[4:5], v44 offset:4096
    ds_read_b64_tr_b16 a[6:7], v44 offset:6144
    v_mfma_f32_16x16x32_bf16 v[184:187], a[44:47], v[124:127], v[184:187]
    s_waitcnt lgkmcnt(8)
    v_mfma_f32_16x16x32_bf16 v[180:183], a[48:51], v[96:99], v[180:183]
    ds_read_b64_tr_b16 a[8:9], v44 offset:8192
    ds_read_b64_tr_b16 a[10:11], v44 offset:10240
    v_mfma_f32_16x16x32_bf16 v[180:183], a[52:55], v[104:107], v[180:183]
    s_waitcnt lgkmcnt(6)
    v_mfma_f32_16x16x32_bf16 v[180:183], a[56:59], v[112:115], v[180:183]
    ds_read_b64_tr_b16 a[12:13], v44 offset:12288
    ds_read_b64_tr_b16 a[14:15], v44 offset:14336
    v_mfma_f32_16x16x32_bf16 v[180:183], a[60:63], v[120:123], v[180:183]
    v_mfma_f32_16x16x32_bf16 v[188:191], a[48:51], v[100:103], v[188:191]
    ds_read_b64_tr_b16 a[16:17], v45 offset:0
    ds_read_b64_tr_b16 a[18:19], v45 offset:2048
    v_mfma_f32_16x16x32_bf16 v[188:191], a[52:55], v[108:111], v[188:191]
    v_mfma_f32_16x16x32_bf16 v[188:191], a[56:59], v[116:119], v[188:191]
    buffer_store_dwordx4 v[12:15], v55, s[48:51], s67 offen offset:3072 sc1
    ds_read_b64_tr_b16 a[20:21], v45 offset:4096
    ds_read_b64_tr_b16 a[22:23], v45 offset:6144
    v_mfma_f32_16x16x32_bf16 v[188:191], a[60:63], v[124:127], v[188:191]
    s_waitcnt lgkmcnt(8)
    v_mfma_f32_16x16x32_bf16 v[128:131], a[0:3], v[64:67], 0
    s_add_u32 s67, s67, 12288
    ds_read_b64_tr_b16 a[24:25], v45 offset:8192
    ds_read_b64_tr_b16 a[26:27], v45 offset:10240
    v_mfma_f32_16x16x32_bf16 v[128:131], a[4:7], v[72:75], v[128:131]
    s_waitcnt lgkmcnt(6)
    v_add_u32 v44, 114688, v54
    v_mfma_f32_16x16x32_bf16 v[128:131], a[8:11], v[80:83], v[128:131]
    s_cmp_eq_u32 s67, s66
    ds_read_b64_tr_b16 a[28:29], v45 offset:12288
    ds_read_b64_tr_b16 a[30:31], v45 offset:14336
    v_mfma_f32_16x16x32_bf16 v[128:131], a[12:15], v[88:91], v[128:131]
    s_cselect_b32 s67, s68, s67
    v_xor_b32 v45, 32, v44
    v_cvt_pk_bf16_f32 v16, v160, v161
    v_mfma_f32_16x16x32_bf16 v[136:139], a[0:3], v[68:71], 0
    ds_read_b64_tr_b16 a[32:33], v46 offset:0
    ds_read_b64_tr_b16 a[34:35], v46 offset:2048
    v_mfma_f32_16x16x32_bf16 v[136:139], a[4:7], v[76:79], v[136:139]
    v_cvt_pk_bf16_f32 v17, v162, v163
    v_cvt_pk_bf16_f32 v18, v164, v165
    v_mfma_f32_16x16x32_bf16 v[136:139], a[8:11], v[84:87], v[136:139]
    ds_read_b64_tr_b16 a[36:37], v46 offset:4096
    ds_read_b64_tr_b16 a[38:39], v46 offset:6144
    v_mfma_f32_16x16x32_bf16 v[136:139], a[12:15], v[92:95], v[136:139]
    s_waitcnt lgkmcnt(8)
L_pg7:
    s_cbranch_execz L_w2_3
    v_cvt_pk_bf16_f32 v19, v166, v167
    v_cvt_pk_bf16_f32 v20, v168, v169
    v_mfma_f32_16x16x32_bf16 v[132:135], a[16:19], v[64:67], 0
    ds_read_b64_tr_b16 a[40:41], v46 offset:8192
    ds_read_b64_tr_b16 a[42:43], v46 offset:10240
    v_mfma_f32_16x16x32_bf16 v[132:135], a[20:23], v[72:75], v[132:135]
    s_waitcnt lgkmcnt(6)
    v_cvt_pk_bf16_f32 v21, v170, v171
    v_cvt_pk_bf16_f32 v22, v172, v173
    v_mfma_f32_16x16x32_bf16 v[132:135], a[24:27], v[80:83], v[132:135]
    buffer_store_dwordx4 v[16:19], v55, s[48:51], s67 offen offset:0 sc1
    ds_read_b64_tr_b16 a[44:45], v46 offset:12288
    ds_read_b64_tr_b16 a[46:47], v46 offset:14336
    v_mfma_f32_16x16x32_bf16 v[132:135], a[28:31], v[88:91], v[132:135]
    v_xor_b32 v46, 64, v44
    v_cvt_pk_bf16_f32 v23, v174, v175
    v_mfma_f32_16x16x32_bf16 v[140:143], a[16:19], v[68:71], 0
    ds_read_b64_tr_b16 a[48:49], v47 offset:0
    ds_read_b64_tr_b16 a[50:51], v47 offset:2048
    v_mfma_f32_16x16x32_bf16 v[140:143], a[20:23], v[76:79], v[140:143]
    v_cvt_pk_bf16_f32 v24, v176, v177
    v_cvt_pk_bf16_f32 v25, v178, v179
    v_mfma_f32_16x16x32_bf16 v[140:143], a[24:27], v[84:87], v[140:143]
    ds_read_b64_tr_b16 a[52:53], v47 offset:4096
    ds_read_b64_tr_b16 a[54:55], v47 offset:6144
    v_mfma_f32_16x16x32_bf16 v[140:143], a[28:31], v[92:95], v[140:143]
    s_waitcnt lgkmcnt(8)
    v_cvt_pk_bf16_f32 v26, v180, v181
    v_cvt_pk_bf16_f32 v27, v182, v183
    v_mfma_f32_16x16x32_bf16 v[144:147], a[32:35], v[64:67], 0
    ds_read_b64_tr_b16 a[56:57], v47 offset:8192
    ds_read_b64_tr_b16 a[58:59], v47 offset:10240
    v_mfma_f32_16x16x32_bf16 v[144:147], a[36:39], v[72:75], v[144:147]
    s_waitcnt lgkmcnt(6)
    v_cvt_pk_bf16_f32 v28, v184, v185
    v_cvt_pk_bf16_f32 v29, v186, v187
    v_mfma_f32_16x16x32_bf16 v[144:147], a[40:43], v[80:83], v[144:147]
    ds_read_b64_tr_b16 a[60:61], v47 offset:12288
    ds_read_b64_tr_b16 a[62:63], v47 offset:14336
    v_mfma_f32_16x16x32_bf16 v[144:147], a[44:47], v[88:91], v[144:147]
    v_xor_b32 v47, 96, v44
    v_cvt_pk_bf16_f32 v30, v188, v189
    v_mfma_f32_16x16x32_bf16 v[152:155], a[32:35], v[68:71], 0
    ds_read_b64_tr_b16 a[0:1], v44 offset:0
    ds_read_b64_tr_b16 a[2:3], v44 offset:2048
    v_mfma_f32_16x16x32_bf16 v[152:155], a[36:39], v[76:79], v[152:155]
    v_cvt_pk_bf16_f32 v31, v190, v191
    v_mfma_f32_16x16x32_bf16 v[152:155], a[40:43], v[84:87], v[152:155]
    buffer_store_dwordx4 v[20:23], v55, s[48:51], s67 offen offset:1024 sc1
    ds_read_b64_tr_b16 a[4:5], v44 offset:4096
    ds_read_b64_tr_b16 a[6:7], v44 offset:6144
    v_mfma_f32_16x16x32_bf16 v[152:155], a[44:47], v[92:95], v[152:155]
    s_waitcnt lgkmcnt(8)
    v_mfma_f32_16x16x32_bf16 v[148:151], a[48:51], v[64:67], 0
    ds_read_b64_tr_b16 a[8:9], v44 offset:8192
    ds_read_b64_tr_b16 a[10:11], v44 offset:10240
    v_mfma_f32_16x16x32_bf16 v[148:151], a[52:55], v[72:75], v[148:151]
    s_waitcnt lgkmcnt(6)
    v_mfma_f32_16x16x32_bf16 v[148:151], a[56:59], v[80:83], v[148:151]
    ds_read_b64_tr_b16 a[12:13], v44 offset:12288
    ds_read_b64_tr_b16 a[14:15], v44 offset:14336
    v_mfma_f32_16x16x32_bf16 v[148:151], a[60:63], v[88:91], v[148:151]
    v_mfma_f32_16x16x32_bf16 v[156:159], a[48:51], v[68:71], 0
    ds_read_b64_tr_b16 a[16:17], v45 offset:0
    ds_read_b64_tr_b16 a[18:19], v45 offset:2048
    v_mfma_f32_16x16x32_bf16 v[156:159], a[52:55], v[76:79], v[156:159]
    v_mfma_f32_16x16x32_bf16 v[156:159], a[56:59], v[84:87], v[156:159]
    ds_read_b64_tr_b16 a[20:21], v45 offset:4096
    ds_read_b64_tr_b16 a[22:23], v45 offset:6144
    v_mfma_f32_16x16x32_bf16 v[156:159], a[60:63], v[92:95], v[156:159]
    s_waitcnt lgkmcnt(8)
    v_mfma_f32_16x16x32_bf16 v[128:131], a[0:3], v[96:99], v[128:131]
    ds_read_b64_tr_b16 a[24:25], v45 offset:8192
    ds_read_b64_tr_b16 a[26:27], v45 offset:10240
    v_mfma_f32_16x16x32_bf16 v[128:131], a[4:7], v[104:107], v[128:131]
    s_waitcnt lgkmcnt(6)
    v_mfma_f32_16x16x32_bf16 v[128:131], a[8:11], v[112:115], v[128:131]
    ds_read_b64_tr_b16 a[28:29], v45 offset:12288
    ds_read_b64_tr_b16 a[30:31], v45 offset:14336
    v_mfma_f32_16x16x32_bf16 v[128:131], a[12:15], v[120:123], v[128:131]
    v_mfma_f32_16x16x32_bf16 v[136:139], a[0:3], v[100:103], v[136:139]
    buffer_store_dwordx4 v[24:27], v55, s[48:51], s67 offen offset:2048 sc1
    ds_read_b64_tr_b16 a[32:33], v46 offset:0
    ds_read_b64_tr_b16 a[34:35], v46 offset:2048
    v_mfma_f32_16x16x32_bf16 v[136:139], a[4:7], v[108:111], v[136:139]
    v_mfma_f32_16x16x32_bf16 v[136:139], a[8:11], v[116:119], v[136:139]
    ds_read_b64_tr_b16 a[36:37], v46 offset:4096
    ds_read_b64_tr_b16 a[38:39], v46 offset:6144
    v_mfma_f32_16x16x32_bf16 v[136:139], a[12:15], v[124:127], v[136:139]
    s_waitcnt lgkmcnt(8)
    v_mfma_f32_16x16x32_bf16 v[132:135], a[16:19], v[96:99], v[132:135]
    ds_read_b64_tr_b16 a[40:41], v46 offset:8192
    ds_read_b64_tr_b16 a[42:43], v46 offset:10240
    v_mfma_f32_16x16x32_bf16 v[132:135], a[20:23], v[104:107], v[132:135]
    s_waitcnt lgkmcnt(6)
    v_mfma_f32_16x16x32_bf16 v[132:135], a[24:27], v[112:115], v[132:135]
    ds_read_b64_tr_b16 a[44:45], v46 offset:12288
    ds_read_b64_tr_b16 a[46:47], v46 offset:14336
    v_mfma_f32_16x16x32_bf16 v[132:135], a[28:31], v[120:123], v[132:135]
    v_mfma_f32_16x16x32_bf16 v[140:143], a[16:19], v[100:103], v[140:143]
    ds_read_b64_tr_b16 a[48:49], v47 offset:0
    ds_read_b64_tr_b16 a[50:51], v47 offset:2048
    v_mfma_f32_16x16x32_bf16 v[140:143], a[20:23], v[108:111], v[140:143]
    v_mfma_f32_16x16x32_bf16 v[140:143], a[24:27], v[116:119], v[140:143]
    ds_read_b64_tr_b16 a[52:53], v47 offset:4096
    ds_read_b64_tr_b16 a[54:55], v47 offset:6144
    v_mfma_f32_16x16x32_bf16 v[140:143], a[28:31], v[124:127], v[140:143]
    s_waitcnt lgkmcnt(8)
    v_mfma_f32_16x16x32_bf16 v[144:147], a[32:35], v[96:99], v[144:147]
    buffer_store_dwordx4 v[28:31], v55, s[48:51], s67 offen offset:3072 sc1
    ds_read_b64_tr_b16 a[56:57], v47 offset:8192
    ds_read_b64_tr_b16 a[58:59], v47 offset:10240
    v_mfma_f32_16x16x32_bf16 v[144:147], a[36:39], v[104:107], v[144:147]
    s_waitcnt lgkmcnt(6)
    v_mfma_f32_16x16x32_bf16 v[144:147], a[40:43], v[112:115], v[144:147]
    ds_read_b64_tr_b16 a[60:61], v47 offset:12288
    ds_read_b64_tr_b16 a[62:63], v47 offset:14336
    v_mfma_f32_16x16x32_bf16 v[144:147], a[44:47], v[120:123], v[144:147]
    s_waitcnt lgkmcnt(4)
    v_cvt_pk_bf16_f32 v192, v128, v129
    v_cvt_pk_bf16_f32 v193, v130, v131
    v_mfma_f32_16x16x32_bf16 v[148:151], a[48:51], v[96:99], v[148:151]
    s_add_u32 s67, s67, 12288
    v_cvt_pk_bf16_f32 v194, v132, v133
    v_cvt_pk_bf16_f32 v195, v134, v135
    v_mfma_f32_16x16x32_bf16 v[148:151], a[52:55], v[104:107], v[148:151]
    s_waitcnt lgkmcnt(0)
    v_cvt_pk_bf16_f32 v196, v136, v137
    v_cvt_pk_bf16_f32 v197, v138, v139
    v_mfma_f32_16x16x32_bf16 v[148:151], a[56:59], v[112:115], v[148:151]
    s_cmp_eq_u32 s67, s66
    v_cvt_pk_bf16_f32 v198, v140, v141
    v_cvt_pk_bf16_f32 v199, v142, v143
    v_mfma_f32_16x16x32_bf16 v[148:151], a[60:63], v[120:123], v[148:151]
    s_cselect_b32 s67, s68, s67
    v_mfma_f32_16x16x32_bf16 v[152:155], a[32:35], v[100:103], v[152:155]
    buffer_store_dwordx4 v[192:195], v55, s[48:51], s67 offen offset:0 sc1
    v_mfma_f32_16x16x32_bf16 v[152:155], a[36:39], v[108:111], v[152:155]
    buffer_store_dwordx4 v[196:199], v55, s[48:51], s67 offen offset:1024 sc1
    v_mfma_f32_16x16x32_bf16 v[152:155], a[40:43], v[116:119], v[152:155]
    v_mfma_f32_16x16x32_bf16 v[152:155], a[44:47], v[124:127], v[152:155]
    v_cvt_pk_bf16_f32 v200, v144, v145
    v_cvt_pk_bf16_f32 v201, v146, v147
    v_mfma_f32_16x16x32_bf16 v[156:159], a[48:51], v[100:103], v[156:159]
    v_cvt_pk_bf16_f32 v202, v148, v149
    v_cvt_pk_bf16_f32 v203, v150, v151
    v_mfma_f32_16x16x32_bf16 v[156:159], a[52:55], v[108:111], v[156:159]
    buffer_store_dwordx4 v[200:203], v55, s[48:51], s67 offen offset:2048 sc1
    v_mfma_f32_16x16x32_bf16 v[156:159], a[56:59], v[116:119], v[156:159]
    v_mfma_f32_16x16x32_bf16 v[156:159], a[60:63], v[124:127], v[156:159]
    v_cvt_pk_bf16_f32 v204, v152, v153
    v_cvt_pk_bf16_f32 v205, v154, v155
    s_nop 0
    s_nop 3
    s_nop 0
    v_cvt_pk_bf16_f32 v206, v156, v157
    v_cvt_pk_bf16_f32 v207, v158, v159
    buffer_store_dwordx4 v[204:207], v55, s[48:51], s67 offen offset:3072 sc1
    v_mov_b32 v53, 7
    s_waitcnt vmcnt(0)
    buffer_store_dword v53, v52, s[44:47], 0 offen sc1
L_tail:
    s_barrier
    s_mov_b32 s21, s25
    s_mul_i32 s54, s27, 16
    s_add_u32 s54, s54, s21
    s_mul_i32 s40, s54, 43
    s_lshr_b32 s40, s40, 7
    s_mul_i32 s53, s40, 3
    s_sub_u32 s88, s54, s53
    s_lshl_b32 s43, s88, 2
    s_and_b32 s53, s40, 3
    s_add_u32 s43, s43, s53
    s_mul_i32 s43, s43, 256
    s_mul_i32 s53, s69, 3072
    s_add_u32 s53, s53, 25165824
    s_add_u32 s36, s14, s53
    s_addc_u32 s37, s15, 0
    s_mov_b32 s38, 3072
    s_mov_b32 s39, 0x20000
    v_mbcnt_lo_u32_b32 v6, -1, 0
    v_mbcnt_hi_u32_b32 v6, -1, v6
    v_and_b32 v7, 15, v6
    v_lshlrev_b32 v3, 2, v7
    buffer_load_dword v5, v3, s[36:39], s43 offen sc1
    v_lshlrev_b32 v2, 4, v6
    v_mul_u32_u24 v4, 1792, v7
    v_and_b32 v7, 48, v6
    v_add_u32 v4, v4, v7
    v_bfe_u32 v16, v6, 3, 1
    v_bfe_u32 v17, v6, 1, 1
    v_lshl_add_u32 v16, v16, 1, v17
    v_bfe_u32 v17, v6, 2, 1
    v_lshrrev_b32 v18, 5, v6
    v_xor_b32 v17, v17, v18
    v_bfe_u32 v18, v6, 4, 1
    v_lshl_add_u32 v17, v17, 1, v18
    v_lshl_add_u32 v16, v17, 2, v16
    v_and_b32 v17, 1, v6
    v_lshlrev_b32 v17, 4, v17
    v_mov_b32 v18, 0x3f80
    v_lshlrev_b32 v17, v17, v18
    v_cmp_eq_u32 vcc, 0, v16
    s_nop 1
    v_cndmask_b32 v8, 0, v17, vcc
    v_cmp_eq_u32 vcc, 1, v16
    s_nop 1
    v_cndmask_b32 v9, 0, v17, vcc
    v_cmp_eq_u32 vcc, 2, v16
    s_nop 1
    v_cndmask_b32 v10, 0, v17, vcc
    v_cmp_eq_u32 vcc, 3, v16
    s_nop 1
    v_cndmask_b32 v11, 0, v17, vcc
    v_cmp_eq_u32 vcc, 4, v16
    s_nop 1
    v_cndmask_b32 v12, 0, v17, vcc
    v_cmp_eq_u32 vcc, 5, v16
    s_nop 1
    v_cndmask_b32 v13, 0, v17, vcc
    v_cmp_eq_u32 vcc, 6, v16
    s_nop 1
    v_cndmask_b32 v14, 0, v17, vcc
    v_cmp_eq_u32 vcc, 7, v16
    s_nop 1
    v_cndmask_b32 v15, 0, v17, vcc
    s_mov_b32 s55, 1048576
    s_mul_i32 s54, s69, 1376256
    s_add_u32 s28, s14, s54
    s_addc_u32 s29, s15, 0
    s_mov_b32 s30, 1376256
    s_mov_b32 s31, 0x20000
    s_mul_i32 s54, s24, 172032
    s_mul_i32 s53, s22, 896
    s_add_u32 s54, s54, s53
    s_add_u32 s32, s18, s54
    s_addc_u32 s33, s19, 0
    s_sub_u32 s34, 1376256, s54
    s_mov_b32 s35, 0x20000
    s_cmp_eq_u32 s88, 0
    s_cselect_b32 s42, 6, 7
    s_cmp_eq_u32 s88, 2
    s_cselect_b32 s42, 7, s42
    s_mov_b32 s41, s40
    s_add_u32 s40, s40, s42
    s_cmp_lt_u32 s40, 20
    s_cselect_b32 s86, 7, 7
    s_cmp_eq_u32 s24, 7
    s_cselect_b32 s59, 0, s24
    s_lshr_b32 s54, s40, 2
    s_add_u32 s54, s54, s59
    s_sub_u32 s53, s54, 7
    s_cselect_b32 s54, s54, s53
    s_and_b32 s53, s40, 3
    s_mul_i32 s52, s54, 3
    s_add_u32 s52, s52, s88
    s_lshl_b32 s52, s52, 2
    s_add_u32 s52, s52, s53
    s_lshl_b32 s44, s52, 10
    s_lshl_b32 s54, s54, 1
    s_lshr_b32 s52, s53, 1
    s_add_u32 s54, s54, s52
    s_lshl_b32 s54, s54, 6
    s_and_b32 s53, s53, 1
    s_lshl_b32 s52, s88, 1
    s_add_u32 s53, s53, s52
    s_mul_i32 s53, s53, 28672
    s_add_u32 s50, s53, s54
    s_lshr_b32 s54, s41, 2
    s_add_u32 s54, s54, s59
    s_sub_u32 s53, s54, 7
    s_cselect_b32 s54, s54, s53
    s_and_b32 s53, s41, 3
    s_mul_i32 s52, s54, 3
    s_add_u32 s52, s52, s88
    s_lshl_b32 s52, s52, 2
    s_add_u32 s52, s52, s53
    s_lshl_b32 s45, s52, 10
    s_lshl_b32 s54, s54, 1
    s_lshr_b32 s52, s53, 1
    s_add_u32 s54, s54, s52
    s_lshl_b32 s54, s54, 6
    s_and_b32 s53, s53, 1
    s_lshl_b32 s52, s88, 1
    s_add_u32 s53, s53, s52
    s_mul_i32 s53, s53, 28672
    s_add_u32 s51, s53, s54
    s_mov_b32 s47, 0
    s_cmp_lt_u32 s41, s42
    s_cbranch_scc1 L_spin2
L_spin1:
    s_waitcnt vmcnt(0)
L_chk1:
    v_cmp_le_u32 vcc, s86, v5
    s_sub_u32 s55, s55, 1
    s_cselect_b32 s48, 0xffff, vcc_lo
    s_and_b32 s48, s48, 0xffff
    s_andn2_b32 s49, s48, s47
    s_cbranch_scc0 L_poll1
    s_or_b32 s47, s47, s48
    s_and_b32 s53, s49, 15
    s_cbranch_scc0 L_sk1_3
    s_bitcmp1_b32 s49, 0
    s_cbranch_scc0 L_sk1_0
    s_waitcnt vmcnt(5)
    s_add_u32 s53, s44, 0
    buffer_load_dwordx4 v[32:35], v2, s[28:31], s53 offen sc1
L_sk1_0:
    s_bitcmp1_b32 s49, 1
    s_cbranch_scc0 L_sk1_1
    s_waitcnt vmcnt(5)
    s_add_u32 s53, s44, 86016
    buffer_load_dwordx4 v[36:39], v2, s[28:31], s53 offen sc1
L_sk1_1:
    s_bitcmp1_b32 s49, 2
    s_cbranch_scc0 L_sk1_2
    s_waitcnt vmcnt(5)
    s_add_u32 s53, s44, 172032
    buffer_load_dwordx4 v[40:43], v2, s[28:31], s53 offen sc1
L_sk1_2:
    s_bitcmp1_b32 s49, 3
    s_cbranch_scc0 L_sk1_3
    s_waitcnt vmcnt(5)
    s_add_u32 s53, s44, 258048
    buffer_load_dwordx4 v[44:47], v2, s[28:31], s53 offen sc1
L_sk1_3:
    s_and_b32 s53, s49, 240
    s_cbranch_scc0 L_sk1_7
    s_bitcmp1_b32 s49, 4
    s_cbranch_scc0 L_sk1_4
    s_waitcnt vmcnt(5)
    s_add_u32 s53, s44, 344064
    buffer_load_dwordx4 v[48:51], v2, s[28:31], s53 offen sc1
L_sk1_4:
    s_bitcmp1_b32 s49, 5
    s_cbranch_scc0 L_sk1_5
    s_waitcnt vmcnt(5)
    s_add_u32 s53, s44, 430080
    buffer_load_dwordx4 v[52:55], v2, s[28:31], s53 offen sc1
L_sk1_5:
    s_bitcmp1_b32 s49, 6
    s_cbranch_scc0 L_sk1_6
    s_waitcnt vmcnt(5)
    s_add_u32 s53, s44, 516096
    buffer_load_dwordx4 v[56:59], v2, s[28:31], s53 offen sc1
L_sk1_6:
    s_bitcmp1_b32 s49, 7
    s_cbranch_scc0 L_sk1_7
    s_waitcnt vmcnt(5)
    s_add_u32 s53, s44, 602112
    buffer_load_dwordx4 v[60:63], v2, s[28:31], s53 offen sc1
L_sk1_7:
    s_and_b32 s53, s49, 3840
    s_cbranch_scc0 L_sk1_11
    s_bitcmp1_b32 s49, 8
    s_cbranch_scc0 L_sk1_8
    s_waitcnt vmcnt(5)
    s_add_u32 s53, s44, 688128
    buffer_load_dwordx4 v[64:67], v2, s[28:31], s53 offen sc1
L_sk1_8:
    s_bitcmp1_b32 s49, 9
    s_cbranch_scc0 L_sk1_9
    s_waitcnt vmcnt(5)
    s_add_u32 s53, s44, 774144
    buffer_load_dwordx4 v[68:71], v2, s[28:31], s53 offen sc1
L_sk1_9:
    s_bitcmp1_b32 s49, 10
    s_cbranch_scc0 L_sk1_10
    s_waitcnt vmcnt(5)
    s_add_u32 s53, s44, 860160
    buffer_load_dwordx4 v[72:75], v2, s[28:31], s53 offen sc1
L_sk1_10:
    s_bitcmp1_b32 s49, 11
    s_cbranch_scc0 L_sk1_11
    s_waitcnt vmcnt(5)
    s_add_u32 s53, s44, 946176
    buffer_load_dwordx4 v[76:79], v2, s[28:31], s53 offen sc1
L_sk1_11:
    s_and_b32 s53, s49, 61440
    s_cbranch_scc0 L_sk1_15
    s_bitcmp1_b32 s49, 12
    s_cbranch_scc0 L_sk1_12
    s_waitcnt vmcnt(5)
    s_add_u32 s53, s44, 1032192
    buffer_load_dwordx4 v[80:83], v2, s[28:31], s53 offen sc1
L_sk1_12:
    s_bitcmp1_b32 s49, 13
    s_cbranch_scc0 L_sk1_13
    s_waitcnt vmcnt(5)
    s_add_u32 s53, s44, 1118208
    buffer_load_dwordx4 v[84:87], v2, s[28:31], s53 offen sc1
L_sk1_13:
    s_bitcmp1_b32 s49, 14
    s_cbranch_scc0 L_sk1_14
    s_waitcnt vmcnt(5)
    s_add_u32 s53, s44, 1204224
    buffer_load_dwordx4 v[88:91], v2, s[28:31], s53 offen sc1
L_sk1_14:
    s_bitcmp1_b32 s49, 15
    s_cbranch_scc0 L_sk1_15
    s_waitcnt vmcnt(5)
    s_add_u32 s53, s44, 1290240
    buffer_load_dwordx4 v[92:95], v2, s[28:31], s53 offen sc1
L_sk1_15:
    s_cmp_eq_u32 s47, 0xffff
    s_cbranch_scc1 L_got1
L_poll1:
    buffer_load_dword v5, v3, s[36:39], s43 offen sc1
    s_branch L_spin1
L_got1:
    s_waitcnt vmcnt(0)
    v_mfma_f32_16x16x32_bf16 v[16:19], v[8:11], v[32:35], 0
    v_mfma_f32_16x16x32_bf16 v[20:23], v[12:15], v[32:35], 0
    v_mfma_f32_16x16x32_bf16 v[16:19], v[8:11], v[36:39], v[16:19]
    v_mfma_f32_16x16x32_bf16 v[20:23], v[12:15], v[36:39], v[20:23]
    v_mfma_f32_16x16x32_bf16 v[16:19], v[8:11], v[40:43], v[16:19]
    v_mfma_f32_16x16x32_bf16 v[20:23], v[12:15], v[40:43], v[20:23]
    v_mfma_f32_16x16x32_bf16 v[16:19], v[8:11], v[44:47], v[16:19]
    v_mfma_f32_16x16x32_bf16 v[20:23], v[12:15], v[44:47], v[20:23]
    v_mfma_f32_16x16x32_bf16 v[16:19], v[8:11], v[48:51], v[16:19]
    v_mfma_f32_16x16x32_bf16 v[20:23], v[12:15], v[48:51], v[20:23]
    v_mfma_f32_16x16x32_bf16 v[16:19], v[8:11], v[52:55], v[16:19]
    v_mfma_f32_16x16x32_bf16 v[20:23], v[12:15], v[52:55], v[20:23]
    v_mfma_f32_16x16x32_bf16 v[16:19], v[8:11], v[56:59], v[16:19]
    v_mfma_f32_16x16x32_bf16 v[20:23], v[12:15], v[56:59], v[20:23]
    v_mfma_f32_16x16x32_bf16 v[16:19], v[8:11], v[60:63], v[16:19]
    v_mfma_f32_16x16x32_bf16 v[20:23], v[12:15], v[60:63], v[20:23]
    v_mfma_f32_16x16x32_bf16 v[16:19], v[8:11], v[64:67], v[16:19]
    v_mfma_f32_16x16x32_bf16 v[20:23], v[12:15], v[64:67], v[20:23]
    v_mfma_f32_16x16x32_bf16 v[16:19], v[8:11], v[68:71], v[16:19]
    v_mfma_f32_16x16x32_bf16 v[20:23], v[12:15], v[68:71], v[20:23]
    v_mfma_f32_16x16x32_bf16 v[16:19], v[8:11], v[72:75], v[16:19]
    v_mfma_f32_16x16x32_bf16 v[20:23], v[12:15], v[72:75], v[20:23]
    v_mfma_f32_16x16x32_bf16 v[16:19], v[8:11], v[76:79], v[16:19]
    v_mfma_f32_16x16x32_bf16 v[20:23], v[12:15], v[76:79], v[20:23]
    v_mfma_f32_16x16x32_bf16 v[16:19], v[8:11], v[80:83], v[16:19]
    v_mfma_f32_16x16x32_bf16 v[20:23], v[12:15], v[80:83], v[20:23]
    v_mfma_f32_16x16x32_bf16 v[16:19], v[8:11], v[84:87], v[16:19]
    v_mfma_f32_16x16x32_bf16 v[20:23], v[12:15], v[84:87], v[20:23]
    v_mfma_f32_16x16x32_bf16 v[16:19], v[8:11], v[88:91], v[16:19]
    v_mfma_f32_16x16x32_bf16 v[20:23], v[12:15], v[88:91], v[20:23]
    v_mfma_f32_16x16x32_bf16 v[16:19], v[8:11], v[92:95], v[16:19]
    v_mfma_f32_16x16x32_bf16 v[20:23], v[12:15], v[92:95], v[20:23]
    s_nop 7
    v_cvt_pk_bf16_f32 v28, v16, v17
    v_cvt_pk_bf16_f32 v29, v18, v19
    v_cvt_pk_bf16_f32 v30, v20, v21
    v_cvt_pk_bf16_f32 v31, v22, v23
    buffer_store_dwordx4 v[28:31], v4, s[32:35], s50 offen
    s_endpgm
L_spin2:
    s_waitcnt vmcnt(0)
L_chk2:
    v_cmp_le_u32 vcc, s86, v5
    s_sub_u32 s55, s55, 1
    s_cselect_b32 s48, 0xffff, vcc_lo
    s_and_b32 s48, s48, 0xffff
    s_andn2_b32 s49, s48, s47
    s_cbranch_scc0 L_poll2
    s_or_b32 s47, s47, s48
    s_and_b32 s53, s49, 15
    s_cbranch_scc0 L_sk2_3
    s_bitcmp1_b32 s49, 0
    s_cbranch_scc0 L_sk2_0
    s_add_u32 s53, s44, 0
    buffer_load_dwordx4 v[32:35], v2, s[28:31], s53 offen sc1
    s_add_u32 s53, s45, 0
    buffer_load_dwordx4 v[96:99], v2, s[28:31], s53 offen sc1
L_sk2_0:
    s_bitcmp1_b32 s49, 1
    s_cbranch_scc0 L_sk2_1
    s_add_u32 s53, s44, 86016
    buffer_load_dwordx4 v[36:39], v2, s[28:31], s53 offen sc1
    s_add_u32 s53, s45, 86016
    buffer_load_dwordx4 v[100:103], v2, s[28:31], s53 offen sc1
L_sk2_1:
    s_bitcmp1_b32 s49, 2
    s_cbranch_scc0 L_sk2_2
    s_add_u32 s53, s44, 172032
    buffer_load_dwordx4 v[40:43], v2, s[28:31], s53 offen sc1
    s_add_u32 s53, s45, 172032
    buffer_load_dwordx4 v[104:107], v2, s[28:31], s53 offen sc1
L_sk2_2:
    s_bitcmp1_b32 s49, 3
    s_cbranch_scc0 L_sk2_3
    s_add_u32 s53, s44, 258048
    buffer_load_dwordx4 v[44:47], v2, s[28:31], s53 offen sc1
    s_add_u32 s53, s45, 258048
    buffer_load_dwordx4 v[108:111], v2, s[28:31], s53 offen sc1
L_sk2_3:
    s_and_b32 s53, s49, 240
    s_cbranch_scc0 L_sk2_7
    s_bitcmp1_b32 s49, 4
    s_cbranch_scc0 L_sk2_4
    s_add_u32 s53, s44, 344064
    buffer_load_dwordx4 v[48:51], v2, s[28:31], s53 offen sc1
    s_add_u32 s53, s45, 344064
    buffer_load_dwordx4 v[112:115], v2, s[28:31], s53 offen sc1
L_sk2_4:
    s_bitcmp1_b32 s49, 5
    s_cbranch_scc0 L_sk2_5
    s_add_u32 s53, s44, 430080
    buffer_load_dwordx4 v[52:55], v2, s[28:31], s53 offen sc1
    s_add_u32 s53, s45, 430080
    buffer_load_dwordx4 v[116:119], v2, s[28:31], s53 offen sc1
L_sk2_5:
    s_bitcmp1_b32 s49, 6
    s_cbranch_scc0 L_sk2_6
    s_add_u32 s53, s44, 516096
    buffer_load_dwordx4 v[56:59], v2, s[28:31], s53 offen sc1
    s_add_u32 s53, s45, 516096
    buffer_load_dwordx4 v[120:123], v2, s[28:31], s53 offen sc1
L_sk2_6:
    s_bitcmp1_b32 s49, 7
    s_cbranch_scc0 L_sk2_7
    s_add_u32 s53, s44, 602112
    buffer_load_dwordx4 v[60:63], v2, s[28:31], s53 offen sc1
    s_add_u32 s53, s45, 602112
    buffer_load_dwordx4 v[124:127], v2, s[28:31], s53 offen sc1
L_sk2_7:
    s_and_b32 s53, s49, 3840
    s_cbranch_scc0 L_sk2_11
    s_bitcmp1_b32 s49, 8
    s_cbranch_scc0 L_sk2_8
    s_add_u32 s53, s44, 688128
    buffer_load_dwordx4 v[64:67], v2, s[28:31], s53 offen sc1
    s_add_u32 s53, s45, 688128
    buffer_load_dwordx4 v[128:131], v2, s[28:31], s53 offen sc1
L_sk2_8:
    s_bitcmp1_b32 s49, 9
    s_cbranch_scc0 L_sk2_9
    s_add_u32 s53, s44, 774144
    buffer_load_dwordx4 v[68:71], v2, s[28:31], s53 offen sc1
    s_add_u32 s53, s45, 774144
    buffer_load_dwordx4 v[132:135], v2, s[28:31], s53 offen sc1
L_sk2_9:
    s_bitcmp1_b32 s49, 10
    s_cbranch_scc0 L_sk2_10
    s_add_u32 s53, s44, 860160
    buffer_load_dwordx4 v[72:75], v2, s[28:31], s53 offen sc1
    s_add_u32 s53, s45, 860160
    buffer_load_dwordx4 v[136:139], v2, s[28:31], s53 offen sc1
L_sk2_10:
    s_bitcmp1_b32 s49, 11
    s_cbranch_scc0 L_sk2_11
    s_add_u32 s53, s44, 946176
    buffer_load_dwordx4 v[76:79], v2, s[28:31], s53 offen sc1
    s_add_u32 s53, s45, 946176
    buffer_load_dwordx4 v[140:143], v2, s[28:31], s53 offen sc1
L_sk2_11:
    s_and_b32 s53, s49, 61440
    s_cbranch_scc0 L_sk2_15
    s_bitcmp1_b32 s49, 12
    s_cbranch_scc0 L_sk2_12
    s_add_u32 s53, s44, 1032192
    buffer_load_dwordx4 v[80:83], v2, s[28:31], s53 offen sc1
    s_add_u32 s53, s45, 1032192
    buffer_load_dwordx4 v[144:147], v2, s[28:31], s53 offen sc1
L_sk2_12:
    s_bitcmp1_b32 s49, 13
    s_cbranch_scc0 L_sk2_13
    s_add_u32 s53, s44, 1118208
    buffer_load_dwordx4 v[84:87], v2, s[28:31], s53 offen sc1
    s_add_u32 s53, s45, 1118208
    buffer_load_dwordx4 v[148:151], v2, s[28:31], s53 offen sc1
L_sk2_13:
    s_bitcmp1_b32 s49, 14
    s_cbranch_scc0 L_sk2_14
    s_add_u32 s53, s44, 1204224
    buffer_load_dwordx4 v[88:91], v2, s[28:31], s53 offen sc1
    s_add_u32 s53, s45, 1204224
    buffer_load_dwordx4 v[152:155], v2, s[28:31], s53 offen sc1
L_sk2_14:
    s_bitcmp1_b32 s49, 15
    s_cbranch_scc0 L_sk2_15
    s_add_u32 s53, s44, 1290240
    buffer_load_dwordx4 v[92:95], v2, s[28:31], s53 offen sc1
    s_add_u32 s53, s45, 1290240
    buffer_load_dwordx4 v[156:159], v2, s[28:31], s53 offen sc1
L_sk2_15:
    s_cmp_eq_u32 s47, 0xffff
    s_cbranch_scc1 L_got2
L_poll2:
    buffer_load_dword v5, v3, s[36:39], s43 offen sc1
    s_branch L_spin2
L_got2:
    s_waitcnt vmcnt(0)
    v_mfma_f32_16x16x32_bf16 v[16:19], v[8:11], v[32:35], 0
    v_mfma_f32_16x16x32_bf16 v[20:23], v[12:15], v[32:35], 0
    v_mfma_f32_16x16x32_bf16 v[16:19], v[8:11], v[36:39], v[16:19]
    v_mfma_f32_16x16x32_bf16 v[20:23], v[12:15], v[36:39], v[20:23]
    v_mfma_f32_16x16x32_bf16 v[16:19], v[8:11], v[40:43], v[16:19]
    v_mfma_f32_16x16x32_bf16 v[20:23], v[12:15], v[40:43], v[20:23]
    v_mfma_f32_16x16x32_bf16 v[16:19], v[8:11], v[44:47], v[16:19]
    v_mfma_f32_16x16x32_bf16 v[20:23], v[12:15], v[44:47], v[20:23]
    v_mfma_f32_16x16x32_bf16 v[16:19], v[8:11], v[48:51], v[16:19]
    v_mfma_f32_16x16x32_bf16 v[20:23], v[12:15], v[48:51], v[20:23]
    v_mfma_f32_16x16x32_bf16 v[16:19], v[8:11], v[52:55], v[16:19]
    v_mfma_f32_16x16x32_bf16 v[20:23], v[12:15], v[52:55], v[20:23]
    v_mfma_f32_16x16x32_bf16 v[16:19], v[8:11], v[56:59], v[16:19]
    v_mfma_f32_16x16x32_bf16 v[20:23], v[12:15], v[56:59], v[20:23]
    v_mfma_f32_16x16x32_bf16 v[16:19], v[8:11], v[60:63], v[16:19]
    v_mfma_f32_16x16x32_bf16 v[20:23], v[12:15], v[60:63], v[20:23]
    v_mfma_f32_16x16x32_bf16 v[16:19], v[8:11], v[64:67], v[16:19]
    v_mfma_f32_16x16x32_bf16 v[20:23], v[12:15], v[64:67], v[20:23]
    v_mfma_f32_16x16x32_bf16 v[16:19], v[8:11], v[68:71], v[16:19]
    v_mfma_f32_16x16x32_bf16 v[20:23], v[12:15], v[68:71], v[20:23]
    v_mfma_f32_16x16x32_bf16 v[16:19], v[8:11], v[72:75], v[16:19]
    v_mfma_f32_16x16x32_bf16 v[20:23], v[12:15], v[72:75], v[20:23]
    v_mfma_f32_16x16x32_bf16 v[16:19], v[8:11], v[76:79], v[16:19]
    v_mfma_f32_16x16x32_bf16 v[20:23], v[12:15], v[76:79], v[20:23]
    v_mfma_f32_16x16x32_bf16 v[16:19], v[8:11], v[80:83], v[16:19]
    v_mfma_f32_16x16x32_bf16 v[20:23], v[12:15], v[80:83], v[20:23]
    v_mfma_f32_16x16x32_bf16 v[16:19], v[8:11], v[84:87], v[16:19]
    v_mfma_f32_16x16x32_bf16 v[20:23], v[12:15], v[84:87], v[20:23]
    v_mfma_f32_16x16x32_bf16 v[16:19], v[8:11], v[88:91], v[16:19]
    v_mfma_f32_16x16x32_bf16 v[20:23], v[12:15], v[88:91], v[20:23]
    v_mfma_f32_16x16x32_bf16 v[16:19], v[8:11], v[92:95], v[16:19]
    v_mfma_f32_16x16x32_bf16 v[20:23], v[12:15], v[92:95], v[20:23]
    v_mfma_f32_16x16x32_bf16 v[160:163], v[8:11], v[96:99], 0
    v_mfma_f32_16x16x32_bf16 v[164:167], v[12:15], v[96:99], 0
    v_mfma_f32_16x16x32_bf16 v[160:163], v[8:11], v[100:103], v[160:163]
    v_mfma_f32_16x16x32_bf16 v[164:167], v[12:15], v[100:103], v[164:167]
    v_mfma_f32_16x16x32_bf16 v[160:163], v[8:11], v[104:107], v[160:163]
    v_mfma_f32_16x16x32_bf16 v[164:167], v[12:15], v[104:107], v[164:167]
    v_mfma_f32_16x16x32_bf16 v[160:163], v[8:11], v[108:111], v[160:163]
    v_mfma_f32_16x16x32_bf16 v[164:167], v[12:15], v[108:111], v[164:167]
    v_mfma_f32_16x16x32_bf16 v[160:163], v[8:11], v[112:115], v[160:163]
    v_mfma_f32_16x16x32_bf16 v[164:167], v[12:15], v[112:115], v[164:167]
    v_cvt_pk_bf16_f32 v24, v16, v17
    v_cvt_pk_bf16_f32 v25, v18, v19
    v_cvt_pk_bf16_f32 v26, v20, v21
    v_cvt_pk_bf16_f32 v27, v22, v23
    buffer_store_dwordx4 v[24:27], v4, s[32:35], s50 offen
    v_mfma_f32_16x16x32_bf16 v[160:163], v[8:11], v[116:119], v[160:163]
    v_mfma_f32_16x16x32_bf16 v[164:167], v[12:15], v[116:119], v[164:167]
    v_mfma_f32_16x16x32_bf16 v[160:163], v[8:11], v[120:123], v[160:163]
    v_mfma_f32_16x16x32_bf16 v[164:167], v[12:15], v[120:123], v[164:167]
    v_mfma_f32_16x16x32_bf16 v[160:163], v[8:11], v[124:127], v[160:163]
    v_mfma_f32_16x16x32_bf16 v[164:167], v[12:15], v[124:127], v[164:167]
    v_mfma_f32_16x16x32_bf16 v[160:163], v[8:11], v[128:131], v[160:163]
    v_mfma_f32_16x16x32_bf16 v[164:167], v[12:15], v[128:131], v[164:167]
    v_mfma_f32_16x16x32_bf16 v[160:163], v[8:11], v[132:135], v[160:163]
    v_mfma_f32_16x16x32_bf16 v[164:167], v[12:15], v[132:135], v[164:167]
    v_mfma_f32_16x16x32_bf16 v[160:163], v[8:11], v[136:139], v[160:163]
    v_mfma_f32_16x16x32_bf16 v[164:167], v[12:15], v[136:139], v[164:167]
    v_mfma_f32_16x16x32_bf16 v[160:163], v[8:11], v[140:143], v[160:163]
    v_mfma_f32_16x16x32_bf16 v[164:167], v[12:15], v[140:143], v[164:167]
    v_mfma_f32_16x16x32_bf16 v[160:163], v[8:11], v[144:147], v[160:163]
    v_mfma_f32_16x16x32_bf16 v[164:167], v[12:15], v[144:147], v[164:167]
    v_mfma_f32_16x16x32_bf16 v[160:163], v[8:11], v[148:151], v[160:163]
    v_mfma_f32_16x16x32_bf16 v[164:167], v[12:15], v[148:151], v[164:167]
    v_mfma_f32_16x16x32_bf16 v[160:163], v[8:11], v[152:155], v[160:163]
    v_mfma_f32_16x16x32_bf16 v[164:167], v[12:15], v[152:155], v[164:167]
    v_mfma_f32_16x16x32_bf16 v[160:163], v[8:11], v[156:159], v[160:163]
    v_mfma_f32_16x16x32_bf16 v[164:167], v[12:15], v[156:159], v[164:167]
    s_nop 7
    v_cvt_pk_bf16_f32 v28, v160, v161
    v_cvt_pk_bf16_f32 v29, v162, v163
    v_cvt_pk_bf16_f32 v30, v164, v165
    v_cvt_pk_bf16_f32 v31, v166, v167
    buffer_store_dwordx4 v[28:31], v4, s[32:35], s51 offen
L_exit:
    s_endpgm
L_rare_a:
    s_call_b64 s[56:57], L_rescale
    s_branch L_rare_ret_a
L_rare_b:
    s_call_b64 s[56:57], L_rescale
    s_branch L_rare_ret_b
L_rare_c:
    s_call_b64 s[56:57], L_rescale
    s_branch L_rare_ret_c
L_rescale:
    v_max3_f32 v62, v0, v1, v2
    v_max3_f32 v63, v8, v9, v10
    v_max3_f32 v62, v62, v3, v4
    v_max3_f32 v63, v63, v11, v12
    v_max3_f32 v62, v62, v5, v6
L_pg8:
    s_cbranch_execz L_w2_4
    v_max3_f32 v63, v63, v13, v14
    v_max_f32 v62, v62, v7
    v_max_f32 v63, v63, v15
    v_mov_b32 v34, v62
    v_mov_b32 v35, v63
    s_nop 1
    v_permlane32_swap_b32 v62, v34
    v_permlane32_swap_b32 v63, v35
    v_max_f32 v62, v62, v34
    v_max_f32 v63, v63, v35
    v_mov_b32 v34, v62
    v_mov_b32 v35, v63
    s_nop 1
    v_permlane16_swap_b32 v62, v34
    v_permlane16_swap_b32 v63, v35
    v_max_f32 v62, v62, v34
    v_max_f32 v63, v63, v35
    v_max_f32 v62, 0, v62
    v_max_f32 v63, 0, v63
    v_exp_f32_e64 v32, -v62
    v_exp_f32_e64 v33, -v63
    v_sub_f32 v52, v52, v62
    v_sub_f32 v53, v53, v62
    v_sub_f32 v54, v54, v62
    v_sub_f32 v55, v55, v62
    v_sub_f32 v56, v56, v63
    v_sub_f32 v57, v57, v63
    v_sub_f32 v58, v58, v63
    v_sub_f32 v59, v59, v63
    v_sub_f32 v0, v0, v62
    v_sub_f32 v1, v1, v62
    v_sub_f32 v2, v2, v62
    v_sub_f32 v3, v3, v62
    v_sub_f32 v4, v4, v62
    v_sub_f32 v5, v5, v62
    v_sub_f32 v6, v6, v62
    v_sub_f32 v7, v7, v62
    v_sub_f32 v8, v8, v63
    v_sub_f32 v9, v9, v63
    v_sub_f32 v10, v10, v63
    v_sub_f32 v11, v11, v63
    v_sub_f32 v12, v12, v63
    v_sub_f32 v13, v13, v63
    v_sub_f32 v14, v14, v63
    v_sub_f32 v15, v15, v63
    v_exp_f32 v16, v0
    v_exp_f32 v24, v8
    v_exp_f32 v17, v1
    v_exp_f32 v25, v9
    v_exp_f32 v18, v2
    v_exp_f32 v26, v10
    v_add_f32 v62, v16, v17
    v_exp_f32 v19, v3
    v_add_f32 v63, v24, v25
    v_exp_f32 v27, v11
    v_add_f32 v62, v62, v18
    v_exp_f32 v20, v4
    v_add_f32 v63, v63, v26
    v_exp_f32 v28, v12
    v_add_f32 v62, v62, v19
    v_exp_f32 v21, v5
    v_add_f32 v63, v63, v27
    v_exp_f32 v29, v13
    v_add_f32 v62, v62, v20
    v_exp_f32 v22, v6
    v_add_f32 v63, v63, v28
    v_exp_f32 v30, v14
    v_add_f32 v62, v62, v21
    v_exp_f32 v23, v7
    v_add_f32 v63, v63, v29
    v_exp_f32 v31, v15
    v_add_f32 v62, v62, v22
    v_add_f32 v63, v63, v30
    v_add_f32 v62, v62, v23
    v_add_f32 v63, v63, v31
    v_mul_f32 v60, v60, v32
    v_mul_f32 v61, v61, v33
    v_mul_f32 v128, v128, v32
    v_mul_f32 v129, v129, v32
    v_mul_f32 v130, v130, v32
    v_mul_f32 v131, v131, v32
    v_mul_f32 v132, v132, v32
    v_mul_f32 v133, v133, v32
    v_mul_f32 v134, v134, v32
    v_mul_f32 v135, v135, v32
    v_mul_f32 v136, v136, v33
    v_mul_f32 v137, v137, v33
    v_mul_f32 v138, v138, v33
    v_mul_f32 v139, v139, v33
    v_mul_f32 v140, v140, v33
    v_mul_f32 v141, v141, v33
    v_mul_f32 v142, v142, v33
    v_mul_f32 v143, v143, v33
    v_mul_f32 v144, v144, v32
    v_mul_f32 v145, v145, v32
    v_mul_f32 v146, v146, v32
    v_mul_f32 v147, v147, v32
    v_mul_f32 v148, v148, v32
    v_mul_f32 v149, v149, v32
    v_mul_f32 v150, v150, v32
    v_mul_f32 v151, v151, v32
    v_mul_f32 v152, v152, v33
    v_mul_f32 v153, v153, v33
    v_mul_f32 v154, v154, v33
    v_mul_f32 v155, v155, v33
    v_mul_f32 v156, v156, v33
    v_mul_f32 v157, v157, v33
    v_mul_f32 v158, v158, v33
    v_mul_f32 v159, v159, v33
    v_mul_f32 v160, v160, v32
    v_mul_f32 v161, v161, v32
    v_mul_f32 v162, v162, v32
    v_mul_f32 v163, v163, v32
    v_mul_f32 v164, v164, v32
    v_mul_f32 v165, v165, v32
    v_mul_f32 v166, v166, v32
    v_mul_f32 v167, v167, v32
    v_mul_f32 v168, v168, v33
    v_mul_f32 v169, v169, v33
    v_mul_f32 v170, v170, v33
    v_mul_f32 v171, v171, v33
    v_mul_f32 v172, v172, v33
    v_mul_f32 v173, v173, v33
    v_mul_f32 v174, v174, v33
    v_mul_f32 v175, v175, v33
    v_mul_f32 v176, v176, v32
    v_mul_f32 v177, v177, v32
    v_mul_f32 v178, v178, v32
    v_mul_f32 v179, v179, v32
    v_mul_f32 v180, v180, v32
    v_mul_f32 v181, v181, v32
    v_mul_f32 v182, v182, v32
    v_mul_f32 v183, v183, v32
    v_mul_f32 v184, v184, v33
    v_mul_f32 v185, v185, v33
    v_mul_f32 v186, v186, v33
    v_mul_f32 v187, v187, v33
    v_mul_f32 v188, v188, v33
    v_mul_f32 v189, v189, v33
    v_mul_f32 v190, v190, v33
    v_mul_f32 v191, v191, v33
    v_mul_f32 v192, v192, v32
    v_mul_f32 v193, v193, v32
    v_mul_f32 v194, v194, v32
    v_mul_f32 v195, v195, v32
    v_mul_f32 v196, v196, v32
    v_mul_f32 v197, v197, v32
    v_mul_f32 v198, v198, v32
    v_mul_f32 v199, v199, v32
    v_mul_f32 v200, v200, v33
    v_mul_f32 v201, v201, v33
    v_mul_f32 v202, v202, v33
    v_mul_f32 v203, v203, v33
    v_mul_f32 v204, v204, v33
    v_mul_f32 v205, v205, v33
    v_mul_f32 v206, v206, v33
    v_mul_f32 v207, v207, v33
    v_mul_f32 v208, v208, v32
    v_mul_f32 v209, v209, v32
    v_mul_f32 v210, v210, v32
    v_mul_f32 v211, v211, v32
    v_mul_f32 v212, v212, v32
    v_mul_f32 v213, v213, v32
    v_mul_f32 v214, v214, v32
    v_mul_f32 v215, v215, v32
    v_mul_f32 v216, v216, v33
    v_mul_f32 v217, v217, v33
    v_mul_f32 v218, v218, v33
    v_mul_f32 v219, v219, v33
    v_mul_f32 v220, v220, v33
    v_mul_f32 v221, v221, v33
    v_mul_f32 v222, v222, v33
    v_mul_f32 v223, v223, v33
    v_mul_f32 v224, v224, v32
    v_mul_f32 v225, v225, v32
    v_mul_f32 v226, v226, v32
    v_mul_f32 v227, v227, v32
    v_mul_f32 v228, v228, v32
    v_mul_f32 v229, v229, v32
    v_mul_f32 v230, v230, v32
    v_mul_f32 v231, v231, v32
    v_mul_f32 v232, v232, v33
    v_mul_f32 v233, v233, v33
    v_mul_f32 v234, v234, v33
    v_mul_f32 v235, v235, v33
    v_mul_f32 v236, v236, v33
    v_mul_f32 v237, v237, v33
    v_mul_f32 v238, v238, v33
    v_mul_f32 v239, v239, v33
    v_mul_f32 v240, v240, v32
    v_mul_f32 v241, v241, v32
    v_mul_f32 v242, v242, v32
    v_mul_f32 v243, v243, v32
    v_mul_f32 v244, v244, v32
    v_mul_f32 v245, v245, v32
    v_mul_f32 v246, v246, v32
    v_mul_f32 v247, v247, v32
    v_mul_f32 v248, v248, v33
    v_mul_f32 v249, v249, v33
    v_mul_f32 v250, v250, v33
    v_mul_f32 v251, v251, v33
    v_mul_f32 v252, v252, v33
    v_mul_f32 v253, v253, v33
    v_mul_f32 v254, v254, v33
    v_mul_f32 v255, v255, v33
    s_nop 1
    s_setpc_b64 s[56:57]
L_code1:
.section .rodata,"a"
.p2align 6
.amdhsa_kernel concat_heads__gqa_block_cached__mha_block_cached__near_ridge_kernel
  .amdhsa_next_free_vgpr 344
  .amdhsa_next_free_sgpr 102
  .amdhsa_accum_offset 256
  .amdhsa_group_segment_fixed_size 0
  .amdhsa_kernarg_size 104
  .amdhsa_user_sgpr_count 2
  .amdhsa_user_sgpr_kernarg_segment_ptr 1
  .amdhsa_system_sgpr_workgroup_id_x 1
  .amdhsa_float_denorm_mode_32 3
.end_amdhsa_kernel
```
